```python
import torch

def _softmax(x, axis=-1):
    return torch.softmax(x, dim=axis)
def _gelu(x):
    return torch.nn.functional.gelu(x, approximate="tanh")
def _silu(x):
    return torch.nn.functional.silu(x)
def _sigmoid(x):
    return torch.sigmoid(x)
def _layernorm(x, axis=-1, eps=1e-5):
    m = x.mean(dim=axis, keepdim=True)
    v = x.var(dim=axis, keepdim=True, unbiased=False)
    return (x - m) / torch.sqrt(v + eps)
def _scatter_add(tgt, idx, src, axis=0):
    return tgt.clone().index_add_(axis, idx, src)
def _segment_sum(src, seg, n):
    out = torch.zeros((n,) + src.shape[1:], dtype=src.dtype)
    return out.index_add_(0, seg, src)
def _pad(x, pw):
    flat = tuple(v for pair in reversed(pw) for v in pair)
    return torch.nn.functional.pad(x, flat)

kernel_name = 'parallel_sum__ssm_conv_h3__dense_activation_mish__prompt'

def setup_inputs():

    _w = (lambda a: (lambda t: t.to(torch.bfloat16) if t.is_floating_point() else t)(torch.as_tensor(a)))
    def _A_setup():
        B, S, D = 1, 2048, 448
        ks = 4
        return {
            "q": _w((lambda *s: torch.randn(*s, dtype=torch.bfloat16) * 0.05)(B, S, D)),
            "k": _w((lambda *s: torch.randn(*s, dtype=torch.bfloat16) * 0.2)(B, S, D)),
            "v": _w((lambda *s: torch.randn(*s, dtype=torch.bfloat16) * 0.2)(B, S, D)),
            "shift_k": _w((lambda *s: torch.randn(*s, dtype=torch.bfloat16) * 0.2)(D, ks) * 0.5),
            "ssm_k": _w((lambda *s: torch.randn(*s, dtype=torch.bfloat16) * 0.8)(D, S) * (1.0 / S ** 0.5)),
            "ssm_D": _w((lambda *s: torch.randn(*s, dtype=torch.bfloat16) * 0.2)(D)),
        }
    _A_in = _A_setup()

    def _B_setup():
        B, S, D, F = 1, 2048, 448, 1792
        return {
            "x": _w((lambda *s: torch.randn(*s, dtype=torch.bfloat16) * 0.05)(B, S, D)),
            "w1": _w((lambda *s: torch.randn(*s, dtype=torch.bfloat16) * 0.8)(D, F) * (D ** -0.5)),
            "b1": _w((lambda *s: torch.randn(*s, dtype=torch.bfloat16) * 0.2)(F)),
            "w2": _w((lambda *s: torch.randn(*s, dtype=torch.bfloat16) * 0.1)(F, D) * (F ** -0.5)),
        }
    _B_in = _B_setup()

    return {
        "A_q": _A_in["q"],
        "A_k": _A_in["k"],
        "A_v": _A_in["v"],
        "A_shift_k": _A_in["shift_k"],
        "A_ssm_k": _A_in["ssm_k"],
        "A_ssm_D": _A_in["ssm_D"],
        "B_x": _B_in["x"],
        "B_w1": _B_in["w1"],
        "B_b1": _B_in["b1"],
        "B_w2": _B_in["w2"],
    }

def reference(A_q, A_k, A_v, A_shift_k, A_ssm_k, A_ssm_D, B_x, B_w1, B_b1, B_w2):
    def _A_ref(q, k, v, shift_k, ssm_k, ssm_D):
        B, S, D = q.shape
        ks = shift_k.shape[-1]
        k_pad = _pad(k, ((0, 0), (ks - 1, 0), (0, 0)))
        k_shift = torch.zeros_like(k)
        for t in range(ks):
            k_shift = k_shift + k_pad[:, t:t + S, :] * shift_k[:, ks - 1 - t][None, None, :]
        kv = k_shift * v
        L = 2 * S
        kv_pad = _pad(kv, ((0, 0), (0, S), (0, 0)))
        kf_pad = _pad(ssm_k, ((0, 0), (0, S)))
        kv_f = (lambda x, axes=(-2,-1): torch.fft.rfft2(x.float(), dim=axes))(kv_pad[:, None, :, :], axes=(1, 2))
        kf_f = (lambda x, axes=(-2,-1): torch.fft.rfft2(x.float(), dim=axes))(kf_pad[:, None, :], axes=(1, 2))
        kf_f = (lambda x, *d: x.permute(*d))(kf_f, 1, 2, 0)
        y_f = kv_f * kf_f[None, :, :, :]
        y = (lambda x, s, axes=(-2,-1): torch.fft.irfft2(x, s=s, dim=axes).to(torch.bfloat16))(y_f, (1, L), axes=(1, 2))[:, 0, :S, :]
        y = y + kv * ssm_D[None, None, :]
        return q * y

    def _B_ref(x, w1, b1, w2):
        h = torch.einsum("bsd,df->bsf", x, w1) + b1
        sp = torch.log1p(torch.exp(-torch.abs(h))) + torch.where(h > 0, h, torch.zeros_like(h))
        act = h * torch.tanh(sp)
        return torch.einsum("bsf,fd->bsd", act, w2)

    x = A_q
    xn = _layernorm(x, axis=-1)
    return x + _A_ref(xn, A_k, A_v, A_shift_k, A_ssm_k, A_ssm_D) + _B_ref(xn, B_w1, B_b1, B_w2)
```

```asm
; @launch grid=(256,1,1) block=(256,1,1) lds=159744
.amdgcn_target "amdgcn-amd-amdhsa--gfx950"

.text
.globl parallel_sum__ssm_conv_h3__dense_activation_mish__prompt_kernel
.p2align 8
.type parallel_sum__ssm_conv_h3__dense_activation_mish__prompt_kernel,@function
parallel_sum__ssm_conv_h3__dense_activation_mish__prompt_kernel:
  s_cmp_ge_u32 s2, 256
  s_cbranch_scc1 L_end
  s_load_dwordx16 s[64:79], s[0:1], 0
  s_load_dwordx8 s[80:87], s[0:1], 64
  s_load_dwordx2 s[88:89], s[0:1], 96
  s_cmp_lt_u32 s2, 32
  s_cbranch_scc1 L_helper
  s_sub_u32 s2, s2, 32
  s_getpc_b64 s[52:53]
        L_pc:
  s_lshr_b32 s54, s2, 3
  s_cmp_ge_u32 s54, 5
  s_cbranch_scc1 L_nopf
  s_lshl_b32 s54, s54, 12
  v_lshlrev_b32 v14, 4, v0
  v_add_u32 v14, s54, v14
  global_load_dwordx4 a[252:255], v14, s[52:53]
L_nopf:
  v_lshrrev_b32 v2, 6, v0
  v_and_b32 v1, 63, v0
  s_and_b32 s9, s2, 7
  s_lshr_b32 s10, s2, 3
  v_readfirstlane_b32 s4, v2
  s_mul_i32 s11, s10, 37
  s_lshr_b32 s11, s11, 8
  s_mul_i32 s6, s11, 7
  s_sub_u32 s6, s10, s6
  s_lshr_b32 s7, s9, 1
  s_lshl_b32 s7, s7, 2
  s_add_u32 s7, s7, s11
  s_and_b32 s9, s9, 1
  s_mul_i32 s8, s9, 7
  s_add_u32 s8, s8, s6
  s_lshl_b32 s5, s7, 1
  s_add_u32 s5, s5, s9
  s_lshl_b32 s3, s11, 1
  s_add_u32 s3, s3, s6
  s_cmp_ge_u32 s3, 7
  s_cselect_b32 s9, 7, 0
  s_sub_u32 s3, s3, s9
  v_lshrrev_b32 v22, 3, v1
  v_lshrrev_b32 v23, 4, v1
  v_and_b32 v24, 7, v1
  s_lshl_b32 s52, s7, 7
  s_lshl_b32 s53, s4, 5
  s_add_u32 s52, s52, s53
  v_add_u32 v25, s52, v22
  v_mul_u32_u24 v25, 896, v25
  v_xor_b32 v26, v24, v23
  v_lshl_add_u32 v2, v26, 4, v25
  v_xor_b32 v26, 4, v26
  v_lshl_add_u32 v3, v26, 4, v25
  v_add_u32 v3, 7168, v3
  s_lshl_b32 s52, s4, 4
  v_add_u32 v25, s52, v23
  v_mul_u32_u24 v25, 3584, v25
  v_and_b32 v26, 15, v1
  v_lshlrev_b32 v27, 2, v23
  v_xor_b32 v26, v26, v27
  v_lshl_add_u32 v25, v26, 4, v25
  s_lshl_b32 s52, s8, 8
  v_add_u32 v4, s52, v25
  s_lshl_b32 s58, s4, 12
  v_add_u32 v28, 12288, v2
  v_add_u32 v29, 11264, v3
  v_add_u32 v3, 0xfffffc00, v3
  v_add_u32 v25, 13312, v4
  v_add_u32 v26, 26624, v4
  v_add_u32 v27, 39936, v4
  s_waitcnt lgkmcnt(0)
  s_mov_b32 s12, s64
  s_mov_b32 s13, s65
  s_mov_b32 s14, 1835008
  s_mov_b32 s15, 0x00020000
  s_mov_b32 s24, s78
  s_mov_b32 s25, s79
  s_mov_b32 s26, 1605632
  s_mov_b32 s27, 0x00020000
  s_add_u32 m0, s58, 0
  s_mov_b32 s59, 0
  buffer_load_dwordx4 v2, s[12:15], s59 offen lds
  buffer_load_dwordx4 v3, s[12:15], s59 offen offset:1024 lds
  buffer_load_dwordx4 v28, s[12:15], s59 offen offset:2048 lds
  buffer_load_dwordx4 v29, s[12:15], s59 offen offset:3072 lds
  s_add_u32 m0, s58, 16384
  s_mov_b32 s60, 0
  buffer_load_dwordx4 v4, s[24:27], s60 offen lds
  buffer_load_dwordx4 v25, s[24:27], s60 offen offset:1024 lds
  buffer_load_dwordx4 v26, s[24:27], s60 offen offset:2048 lds
  buffer_load_dwordx4 v27, s[24:27], s60 offen offset:3072 lds
  s_mov_b32 s28, s88
  s_mov_b32 s29, s89
  s_mov_b32 s30, 13631488
  s_mov_b32 s31, 0x00020000
  v_mov_b32 v14, 12582912
  buffer_load_dword v56, v14, s[28:31], 0 offen sc1
  s_mov_b32 s16, s66
  s_mov_b32 s17, s67
  s_mov_b32 s18, 1835008
  s_mov_b32 s19, 0x00020000
  s_mov_b32 s20, s68
  s_mov_b32 s21, s69
  s_mov_b32 s22, 1835008
  s_mov_b32 s23, 0x00020000
  s_mov_b32 s44, s70
  s_mov_b32 s45, s71
  s_mov_b32 s32, s82
  s_mov_b32 s33, s83
  s_mov_b32 s34, 1605632
  s_mov_b32 s35, 0x00020000
  s_mov_b32 s36, s72
  s_mov_b32 s37, s73
  s_mov_b32 s38, 1835008
  s_mov_b32 s39, 0x00020000
  s_mov_b32 s40, s84
  s_mov_b32 s41, s85
  s_mov_b32 s42, 1835008
  s_mov_b32 s43, 0x00020000
  s_mov_b32 s46, s74
  s_mov_b32 s47, s75
  s_mov_b32 s48, s80
  s_mov_b32 s49, s81
  s_add_u32 s67, s3, 1
  s_cmp_eq_u32 s67, 7
  s_cselect_b32 s67, 0, s67
  s_add_u32 s68, s67, 1
  s_cmp_eq_u32 s68, 7
  s_cselect_b32 s68, 0, s68
  s_add_u32 s69, s68, 1
  s_cmp_eq_u32 s69, 7
  s_cselect_b32 s69, 0, s69
  s_add_u32 s70, s69, 1
  s_cmp_eq_u32 s70, 7
  s_cselect_b32 s70, 0, s70
  s_add_u32 s71, s70, 1
  s_cmp_eq_u32 s71, 7
  s_cselect_b32 s71, 0, s71
  s_add_u32 s72, s71, 1
  s_cmp_eq_u32 s72, 7
  s_cselect_b32 s72, 0, s72
  v_and_b32 v14, 31, v1
  v_lshrrev_b32 v15, 5, v1
  v_bfe_u32 v16, v1, 1, 3
  v_lshlrev_b32 v17, 7, v14
  v_add_u32 v17, s58, v17
  v_or_b32 v18, 0, v15
  v_xor_b32 v18, v18, v16
  v_lshl_add_u32 v6, v18, 4, v17
  v_or_b32 v18, 2, v15
  v_xor_b32 v18, v18, v16
  v_lshl_add_u32 v7, v18, 4, v17
  v_or_b32 v18, 4, v15
  v_xor_b32 v18, v18, v16
  v_lshl_add_u32 v8, v18, 4, v17
  v_or_b32 v18, 6, v15
  v_xor_b32 v18, v18, v16
  v_lshl_add_u32 v9, v18, 4, v17
  v_bfe_u32 v14, v1, 2, 2
  v_lshrrev_b32 v15, 5, v1
  v_lshl_add_u32 v15, v15, 3, v14
  v_lshlrev_b32 v15, 8, v15
  v_bfe_u32 v16, v1, 4, 1
  v_lshlrev_b32 v16, 5, v16
  v_and_b32 v17, 3, v1
  v_lshl_add_u32 v16, v17, 3, v16
  v_add_u32 v15, v15, v16
  v_add_u32 v15, 16384, v15
  s_add_u32 s52, s4, 0
  s_and_b32 s52, s52, 3
  v_xor_b32 v18, s52, v14
  v_lshl_add_u32 v10, v18, 6, v15
  s_add_u32 s52, s4, 1
  s_and_b32 s52, s52, 3
  v_xor_b32 v18, s52, v14
  v_lshl_add_u32 v11, v18, 6, v15
  s_add_u32 s52, s4, 2
  s_and_b32 s52, s52, 3
  v_xor_b32 v18, s52, v14
  v_lshl_add_u32 v12, v18, 6, v15
  s_add_u32 s52, s4, 3
  s_and_b32 s52, s52, 3
  v_xor_b32 v18, s52, v14
  v_lshl_add_u32 v13, v18, 6, v15
  v_mov_b32 v216, 0x3f803f80
  v_mov_b32 v217, 0x3f803f80
  v_and_b32 v24, 31, v1
  s_lshl_b32 s52, s8, 7
  v_add_u32 v24, s52, v24
  v_lshlrev_b32 v24, 1, v24
  s_add_u32 m0, s58, 32768
  s_mov_b32 s59, 128
  buffer_load_dwordx4 v2, s[12:15], s59 offen lds
  buffer_load_dwordx4 v3, s[12:15], s59 offen offset:1024 lds
  buffer_load_dwordx4 v28, s[12:15], s59 offen offset:2048 lds
  buffer_load_dwordx4 v29, s[12:15], s59 offen offset:3072 lds
  s_add_u32 m0, s58, 49152
  s_mov_b32 s60, 229376
  buffer_load_dwordx4 v4, s[24:27], s60 offen lds
  buffer_load_dwordx4 v25, s[24:27], s60 offen offset:1024 lds
  buffer_load_dwordx4 v26, s[24:27], s60 offen offset:2048 lds
  buffer_load_dwordx4 v27, s[24:27], s60 offen offset:3072 lds
  v_lshrrev_b32 v14, 3, v1
  v_bfe_u32 v15, v1, 4, 1
  s_and_b32 s52, s4, 1
  s_lshl_b32 s52, s52, 1
  v_or_b32 v16, s52, v15
  v_lshlrev_b32 v16, 1, v16
  v_and_b32 v22, 7, v1
  v_xor_b32 v16, v16, v22
  v_lshlrev_b32 v15, 1, v15
  v_xor_b32 v15, v15, v22
  s_lshl_b32 s52, s5, 6
  s_lshl_b32 s53, s4, 4
  s_add_u32 s53, s52, s53
  v_add_u32 v22, s53, v14
  v_mul_u32_u24 v22, 896, v22
  s_lshl_b32 s53, s6, 7
  v_add_u32 v22, s53, v22
  v_lshl_add_u32 v19, v16, 4, v22
  v_add_u32 v23, 7168, v19
  v_subrev_u32 v17, 7168, v19
  v_mov_b32 v18, v19
  v_add_u32 v22, s52, v14
  v_mul_u32_u24 v22, 896, v22
  v_add3_u32 v22, v22, s53, 0
  v_lshl_add_u32 v20, v15, 4, v22
  v_add_u32 v20, 50176, v20
  v_and_b32 v21, 15, v1
  s_lshl_b32 s52, s6, 6
  s_lshl_b32 s53, s4, 4
  s_add_u32 s52, s52, s53
  v_add_u32 v21, s52, v21
  v_lshlrev_b32 v21, 3, v21
  s_waitcnt vmcnt(9)
  s_barrier
  ds_read_b128 v[128:131], v6 offset:0
  ds_read_b64_tr_b16 v[148:149], v10 offset:0
  ds_read_b64_tr_b16 v[150:151], v10 offset:1024
  ds_read_b64_tr_b16 v[168:169], v11 offset:0
  ds_read_b64_tr_b16 v[170:171], v11 offset:1024
  ds_read_b64_tr_b16 v[172:173], v12 offset:0
  ds_read_b64_tr_b16 v[174:175], v12 offset:1024
  ds_read_b64_tr_b16 v[176:177], v13 offset:0
  ds_read_b64_tr_b16 v[178:179], v13 offset:1024
  s_waitcnt lgkmcnt(0)
  ds_read_b128 v[132:135], v7 offset:0
  ds_read_b64_tr_b16 v[152:153], v10 offset:4096
  ds_read_b64_tr_b16 v[154:155], v10 offset:5120
  v_mfma_f32_32x32x16_bf16 v[64:79], v[148:151], v[128:131], 0
  ds_read_b64_tr_b16 v[180:181], v11 offset:4096
  ds_read_b64_tr_b16 v[182:183], v11 offset:5120
  ds_read_b64_tr_b16 v[184:185], v12 offset:4096
  ds_read_b64_tr_b16 v[186:187], v12 offset:5120
  ds_read_b64_tr_b16 v[188:189], v13 offset:4096
  ds_read_b64_tr_b16 v[190:191], v13 offset:5120
  v_mfma_f32_32x32x16_bf16 v[80:95], v[168:171], v[128:131], 0
  s_add_u32 m0, s58, 65536
  s_mov_b32 s59, 256
  buffer_load_dwordx4 v2, s[12:15], s59 offen lds
  v_mfma_f32_32x32x16_bf16 v[96:111], v[172:175], v[128:131], 0
  buffer_load_dwordx4 v3, s[12:15], s59 offen offset:1024 lds
  v_mfma_f32_32x32x16_bf16 v[112:127], v[176:179], v[128:131], 0
  buffer_load_dwordx4 v28, s[12:15], s59 offen offset:2048 lds
  s_waitcnt lgkmcnt(0)
  ds_read_b128 v[136:139], v8 offset:0
  ds_read_b64_tr_b16 v[156:157], v10 offset:8192
  ds_read_b64_tr_b16 v[158:159], v10 offset:9216
  v_mfma_f32_32x32x16_bf16 v[64:79], v[152:155], v[132:135], v[64:79]
  ds_read_b64_tr_b16 v[168:169], v11 offset:8192
  ds_read_b64_tr_b16 v[170:171], v11 offset:9216
  ds_read_b64_tr_b16 v[172:173], v12 offset:8192
  ds_read_b64_tr_b16 v[174:175], v12 offset:9216
  ds_read_b64_tr_b16 v[176:177], v13 offset:8192
  ds_read_b64_tr_b16 v[178:179], v13 offset:9216
  v_mfma_f32_32x32x16_bf16 v[80:95], v[180:183], v[132:135], v[80:95]
  buffer_load_dwordx4 v29, s[12:15], s59 offen offset:3072 lds
  v_mfma_f32_32x32x16_bf16 v[96:111], v[184:187], v[132:135], v[96:111]
  s_add_u32 m0, s58, 81920
  s_mov_b32 s60, 458752
  buffer_load_dwordx4 v4, s[24:27], s60 offen lds
  v_mfma_f32_32x32x16_bf16 v[112:127], v[188:191], v[132:135], v[112:127]
  buffer_load_dwordx4 v25, s[24:27], s60 offen offset:1024 lds
  s_waitcnt lgkmcnt(0)
  ds_read_b128 v[140:143], v9 offset:0
  ds_read_b64_tr_b16 v[160:161], v10 offset:12288
  ds_read_b64_tr_b16 v[162:163], v10 offset:13312
  v_mfma_f32_32x32x16_bf16 v[64:79], v[156:159], v[136:139], v[64:79]
  ds_read_b64_tr_b16 v[180:181], v11 offset:12288
  ds_read_b64_tr_b16 v[182:183], v11 offset:13312
  ds_read_b64_tr_b16 v[184:185], v12 offset:12288
  ds_read_b64_tr_b16 v[186:187], v12 offset:13312
  ds_read_b64_tr_b16 v[188:189], v13 offset:12288
  ds_read_b64_tr_b16 v[190:191], v13 offset:13312
  v_mfma_f32_32x32x16_bf16 v[80:95], v[168:171], v[136:139], v[80:95]
  buffer_load_dwordx4 v26, s[24:27], s60 offen offset:2048 lds
  v_mfma_f32_32x32x16_bf16 v[96:111], v[172:175], v[136:139], v[96:111]
  buffer_load_dwordx4 v27, s[24:27], s60 offen offset:3072 lds
  v_mfma_f32_32x32x16_bf16 v[112:127], v[176:179], v[136:139], v[112:127]
  s_lshl_b32 s54, s4, 11
  s_add_u32 m0, s54, 98304
  s_nop 0
  buffer_load_dwordx4 v17, s[16:19], 0 offen lds
  s_waitcnt lgkmcnt(0)
  s_waitcnt vmcnt(9)
  s_barrier
  v_readfirstlane_b32 s50, v56
  s_nop 3
  s_mul_i32 s50, s50, 0x9e3779b1
  s_add_u32 s50, s50, 0x7f4a7c15
  ds_read_b128 v[144:147], v6 offset:32768
  ds_read_b64_tr_b16 v[164:165], v10 offset:32768
  ds_read_b64_tr_b16 v[166:167], v10 offset:33792
  v_mfma_f32_32x32x16_bf16 v[64:79], v[160:163], v[140:143], v[64:79]
  ds_read_b64_tr_b16 v[168:169], v11 offset:32768
  ds_read_b64_tr_b16 v[170:171], v11 offset:33792
  ds_read_b64_tr_b16 v[172:173], v12 offset:32768
  ds_read_b64_tr_b16 v[174:175], v12 offset:33792
  ds_read_b64_tr_b16 v[176:177], v13 offset:32768
  ds_read_b64_tr_b16 v[178:179], v13 offset:33792
  v_mfma_f32_32x32x16_bf16 v[80:95], v[180:183], v[140:143], v[80:95]
  s_add_u32 m0, s58, 0
  s_mov_b32 s59, 384
  buffer_load_dwordx4 v2, s[12:15], s59 offen lds
  v_mfma_f32_32x32x16_bf16 v[96:111], v[184:187], v[140:143], v[96:111]
  buffer_load_dwordx4 v3, s[12:15], s59 offen offset:1024 lds
  v_mfma_f32_32x32x16_bf16 v[112:127], v[188:191], v[140:143], v[112:127]
  s_lshl_b32 s54, s4, 11
  s_add_u32 m0, s54, 99328
  s_nop 0
  buffer_load_dwordx4 v18, s[16:19], 0 offen lds
  s_waitcnt lgkmcnt(0)
  ds_read_b128 v[128:131], v7 offset:32768
  ds_read_b64_tr_b16 v[148:149], v10 offset:36864
  ds_read_b64_tr_b16 v[150:151], v10 offset:37888
  v_mfma_f32_32x32x16_bf16 v[64:79], v[164:167], v[144:147], v[64:79]
  ds_read_b64_tr_b16 v[180:181], v11 offset:36864
  ds_read_b64_tr_b16 v[182:183], v11 offset:37888
  ds_read_b64_tr_b16 v[184:185], v12 offset:36864
  ds_read_b64_tr_b16 v[186:187], v12 offset:37888
  ds_read_b64_tr_b16 v[188:189], v13 offset:36864
  ds_read_b64_tr_b16 v[190:191], v13 offset:37888
  v_mfma_f32_32x32x16_bf16 v[80:95], v[168:171], v[144:147], v[80:95]
  s_add_u32 m0, s58, 0
  s_nop 0
  buffer_load_dwordx4 v28, s[12:15], s59 offen offset:2048 lds
  v_mfma_f32_32x32x16_bf16 v[96:111], v[172:175], v[144:147], v[96:111]
  buffer_load_dwordx4 v29, s[12:15], s59 offen offset:3072 lds
  v_mfma_f32_32x32x16_bf16 v[112:127], v[176:179], v[144:147], v[112:127]
  s_lshl_b32 s54, s4, 11
  s_add_u32 m0, s54, 107520
  s_nop 0
  buffer_load_dwordx4 v19, s[20:23], 0 offen lds
  s_waitcnt lgkmcnt(0)
  ds_read_b128 v[132:135], v8 offset:32768
  ds_read_b64_tr_b16 v[152:153], v10 offset:40960
  ds_read_b64_tr_b16 v[154:155], v10 offset:41984
  v_mfma_f32_32x32x16_bf16 v[64:79], v[148:151], v[128:131], v[64:79]
  ds_read_b64_tr_b16 v[168:169], v11 offset:40960
  ds_read_b64_tr_b16 v[170:171], v11 offset:41984
  ds_read_b64_tr_b16 v[172:173], v12 offset:40960
  ds_read_b64_tr_b16 v[174:175], v12 offset:41984
  ds_read_b64_tr_b16 v[176:177], v13 offset:40960
  ds_read_b64_tr_b16 v[178:179], v13 offset:41984
  v_mfma_f32_32x32x16_bf16 v[80:95], v[180:183], v[128:131], v[80:95]
  s_add_u32 m0, s58, 16384
  s_mov_b32 s60, 688128
  buffer_load_dwordx4 v4, s[24:27], s60 offen lds
  v_mfma_f32_32x32x16_bf16 v[96:111], v[184:187], v[128:131], v[96:111]
  buffer_load_dwordx4 v25, s[24:27], s60 offen offset:1024 lds
  v_mfma_f32_32x32x16_bf16 v[112:127], v[188:191], v[128:131], v[112:127]
  s_lshl_b32 s54, s4, 11
  s_add_u32 m0, s54, 108544
  s_nop 0
  buffer_load_dwordx4 v23, s[20:23], 0 offen lds
  s_waitcnt lgkmcnt(0)
  ds_read_b128 v[136:139], v9 offset:32768
  ds_read_b64_tr_b16 v[156:157], v10 offset:45056
  ds_read_b64_tr_b16 v[158:159], v10 offset:46080
  v_mfma_f32_32x32x16_bf16 v[64:79], v[152:155], v[132:135], v[64:79]
  ds_read_b64_tr_b16 v[180:181], v11 offset:45056
  ds_read_b64_tr_b16 v[182:183], v11 offset:46080
  ds_read_b64_tr_b16 v[184:185], v12 offset:45056
  ds_read_b64_tr_b16 v[186:187], v12 offset:46080
  ds_read_b64_tr_b16 v[188:189], v13 offset:45056
  ds_read_b64_tr_b16 v[190:191], v13 offset:46080
  v_mfma_f32_32x32x16_bf16 v[80:95], v[168:171], v[132:135], v[80:95]
  s_add_u32 m0, s58, 16384
  s_nop 0
  buffer_load_dwordx4 v26, s[24:27], s60 offen offset:2048 lds
  v_mfma_f32_32x32x16_bf16 v[96:111], v[172:175], v[132:135], v[96:111]
  buffer_load_dwordx4 v27, s[24:27], s60 offen offset:3072 lds
  v_mfma_f32_32x32x16_bf16 v[112:127], v[176:179], v[132:135], v[112:127]
  s_cmp_lg_u32 s4, 0
  s_cbranch_scc1 L_skipk8
  s_mov_b32 m0, 106496
  s_nop 0
  buffer_load_dwordx4 v20, s[16:19], 0 offen lds
        L_skipk8:
  global_load_dwordx2 v[50:51], v21, s[44:45]
  s_waitcnt lgkmcnt(0)
  s_waitcnt vmcnt(13)
  s_barrier
  v_add_u32 v6, 0x10000, v6
  v_add_u32 v7, 0x10000, v7
  v_add_u32 v8, 0x10000, v8
  v_add_u32 v9, 0x10000, v9
  v_add_u32 v10, 0x10000, v10
  v_add_u32 v11, 0x10000, v11
  v_add_u32 v12, 0x10000, v12
  v_add_u32 v13, 0x10000, v13
  ds_read_b128 v[140:143], v6 offset:0
  ds_read_b64_tr_b16 v[160:161], v10 offset:0
  ds_read_b64_tr_b16 v[162:163], v10 offset:1024
  v_mfma_f32_32x32x16_bf16 v[64:79], v[156:159], v[136:139], v[64:79]
  ds_read_b64_tr_b16 v[168:169], v11 offset:0
  ds_read_b64_tr_b16 v[170:171], v11 offset:1024
  ds_read_b64_tr_b16 v[172:173], v12 offset:0
  ds_read_b64_tr_b16 v[174:175], v12 offset:1024
  ds_read_b64_tr_b16 v[176:177], v13 offset:0
  ds_read_b64_tr_b16 v[178:179], v13 offset:1024
  v_lshrrev_b32 v14, 4, v1
  v_bfe_u32 v16, v1, 2, 2
  v_lshl_add_u32 v17, v14, 4, v16
  v_lshlrev_b32 v17, 7, v17
  v_and_b32 v18, 3, v1
  v_mfma_f32_32x32x16_bf16 v[80:95], v[180:183], v[136:139], v[80:95]
  s_add_u32 m0, s58, 32768
  s_mov_b32 s59, 512
  buffer_load_dwordx4 v2, s[12:15], s59 offen lds
  v_lshl_add_u32 v17, v18, 3, v17
  v_lshrrev_b32 v16, 1, v16
  v_and_b32 v18, 1, v14
  v_lshl_or_b32 v16, v18, 1, v16
  v_xor_b32 v16, s4, v16
  v_mfma_f32_32x32x16_bf16 v[96:111], v[184:187], v[136:139], v[96:111]
  buffer_load_dwordx4 v3, s[12:15], s59 offen offset:1024 lds
  v_lshl_add_u32 v19, v16, 5, v17
  v_xor_b32 v16, 2, v16
  v_lshl_add_u32 v20, v16, 5, v17
  v_add_u32 v21, 107520, v19
  v_add_u32 v19, 98304, v19
  v_mfma_f32_32x32x16_bf16 v[112:127], v[188:191], v[136:139], v[112:127]
  v_add_u32 v20, 98304, v20
  s_waitcnt lgkmcnt(0)
  ds_read_b128 v[144:147], v7 offset:0
  ds_read_b64_tr_b16 v[164:165], v10 offset:4096
  ds_read_b64_tr_b16 v[166:167], v10 offset:5120
  v_mfma_f32_32x32x16_bf16 v[64:79], v[160:163], v[140:143], v[64:79]
  ds_read_b64_tr_b16 v[180:181], v11 offset:4096
  ds_read_b64_tr_b16 v[182:183], v11 offset:5120
  ds_read_b64_tr_b16 v[184:185], v12 offset:4096
  ds_read_b64_tr_b16 v[186:187], v12 offset:5120
  ds_read_b64_tr_b16 v[188:189], v13 offset:4096
  ds_read_b64_tr_b16 v[190:191], v13 offset:5120
  v_mfma_f32_32x32x16_bf16 v[80:95], v[168:171], v[140:143], v[80:95]
  buffer_load_dwordx4 v28, s[12:15], s59 offen offset:2048 lds
  v_mfma_f32_32x32x16_bf16 v[96:111], v[172:175], v[140:143], v[96:111]
  buffer_load_dwordx4 v29, s[12:15], s59 offen offset:3072 lds
  v_mfma_f32_32x32x16_bf16 v[112:127], v[176:179], v[140:143], v[112:127]
  s_waitcnt lgkmcnt(0)
  ds_read_b128 v[128:131], v8 offset:0
  ds_read_b64_tr_b16 v[148:149], v10 offset:8192
  ds_read_b64_tr_b16 v[150:151], v10 offset:9216
  v_mfma_f32_32x32x16_bf16 v[64:79], v[164:167], v[144:147], v[64:79]
  ds_read_b64_tr_b16 v[168:169], v11 offset:8192
  ds_read_b64_tr_b16 v[170:171], v11 offset:9216
  ds_read_b64_tr_b16 v[172:173], v12 offset:8192
  ds_read_b64_tr_b16 v[174:175], v12 offset:9216
  ds_read_b64_tr_b16 v[176:177], v13 offset:8192
  ds_read_b64_tr_b16 v[178:179], v13 offset:9216
  v_mfma_f32_32x32x16_bf16 v[80:95], v[180:183], v[144:147], v[80:95]
  s_add_u32 m0, s58, 49152
  s_mov_b32 s60, 917504
  buffer_load_dwordx4 v4, s[24:27], s60 offen lds
  v_mfma_f32_32x32x16_bf16 v[96:111], v[184:187], v[144:147], v[96:111]
  buffer_load_dwordx4 v25, s[24:27], s60 offen offset:1024 lds
  v_mfma_f32_32x32x16_bf16 v[112:127], v[188:191], v[144:147], v[112:127]
  s_waitcnt lgkmcnt(0)
  ds_read_b128 v[132:135], v9 offset:0
  ds_read_b64_tr_b16 v[152:153], v10 offset:12288
  ds_read_b64_tr_b16 v[154:155], v10 offset:13312
  v_mfma_f32_32x32x16_bf16 v[64:79], v[148:151], v[128:131], v[64:79]
  ds_read_b64_tr_b16 v[180:181], v11 offset:12288
  ds_read_b64_tr_b16 v[182:183], v11 offset:13312
  ds_read_b64_tr_b16 v[184:185], v12 offset:12288
  ds_read_b64_tr_b16 v[186:187], v12 offset:13312
  ds_read_b64_tr_b16 v[188:189], v13 offset:12288
  ds_read_b64_tr_b16 v[190:191], v13 offset:13312
  v_mfma_f32_32x32x16_bf16 v[80:95], v[168:171], v[128:131], v[80:95]
  buffer_load_dwordx4 v26, s[24:27], s60 offen offset:2048 lds
  v_mfma_f32_32x32x16_bf16 v[96:111], v[172:175], v[128:131], v[96:111]
  buffer_load_dwordx4 v27, s[24:27], s60 offen offset:3072 lds
  v_mfma_f32_32x32x16_bf16 v[112:127], v[176:179], v[128:131], v[112:127]
  s_waitcnt lgkmcnt(0)
  s_waitcnt vmcnt(9)
  s_waitcnt vmcnt(8)
  s_barrier
  v_add_u32 v6, 0xffff0000, v6
  v_add_u32 v7, 0xffff0000, v7
  v_add_u32 v8, 0xffff0000, v8
  v_add_u32 v9, 0xffff0000, v9
  v_add_u32 v10, 0xffff0000, v10
  v_add_u32 v11, 0xffff0000, v11
  v_add_u32 v12, 0xffff0000, v12
  v_add_u32 v13, 0xffff0000, v13
  ds_read_b128 v[136:139], v6 offset:0
  ds_read_b64_tr_b16 v[156:157], v10 offset:0
  ds_read_b64_tr_b16 v[158:159], v10 offset:1024
  v_mfma_f32_32x32x16_bf16 v[64:79], v[152:155], v[132:135], v[64:79]
  ds_read_b64_tr_b16 v[168:169], v11 offset:0
  ds_read_b64_tr_b16 v[170:171], v11 offset:1024
  ds_read_b64_tr_b16 v[172:173], v12 offset:0
  ds_read_b64_tr_b16 v[174:175], v12 offset:1024
  ds_read_b64_tr_b16 v[176:177], v13 offset:0
  ds_read_b64_tr_b16 v[178:179], v13 offset:1024
  ds_read_b64_tr_b16 v[32:33], v19 offset:512
  ds_read_b64_tr_b16 v[34:35], v19 offset:1024
  ds_read_b64_tr_b16 v[36:37], v19 offset:1536
  ds_read_b64_tr_b16 v[38:39], v20 offset:2048
  ds_read_b64_tr_b16 v[40:41], v20 offset:2560
  v_mfma_f32_32x32x16_bf16 v[80:95], v[180:183], v[132:135], v[80:95]
  s_add_u32 m0, s58, 65536
  s_mov_b32 s59, 640
  buffer_load_dwordx4 v2, s[12:15], s59 offen lds
  ds_read_b64_tr_b16 v[42:43], v21 offset:0
  ds_read_b64_tr_b16 v[44:45], v21 offset:512
  ds_read_b64_tr_b16 v[46:47], v21 offset:1024
  ds_read_b64_tr_b16 v[48:49], v21 offset:1536
  v_lshlrev_b32 v52, 16, v50
  v_mfma_f32_32x32x16_bf16 v[96:111], v[184:187], v[132:135], v[96:111]
  buffer_load_dwordx4 v3, s[12:15], s59 offen offset:1024 lds
  v_and_b32 v53, 0xffff0000, v50
  v_lshlrev_b32 v54, 16, v51
  v_and_b32 v55, 0xffff0000, v51
  v_and_b32 v16, 15, v1
  v_lshlrev_b32 v17, 1, v14
  v_mfma_f32_32x32x16_bf16 v[112:127], v[188:191], v[132:135], v[112:127]
  v_sub_u32 v17, 6, v17
  v_and_b32 v18, 7, v1
  v_xor_b32 v17, v17, v18
  s_waitcnt lgkmcnt(4)
  v_and_b32 v219, 0xffff0000, v32
  ds_read_b128 v[140:143], v7 offset:0
  ds_read_b64_tr_b16 v[160:161], v10 offset:4096
  ds_read_b64_tr_b16 v[162:163], v10 offset:5120
  v_mfma_f32_32x32x16_bf16 v[64:79], v[156:159], v[136:139], v[64:79]
  ds_read_b64_tr_b16 v[180:181], v11 offset:4096
  ds_read_b64_tr_b16 v[182:183], v11 offset:5120
  ds_read_b64_tr_b16 v[184:185], v12 offset:4096
  ds_read_b64_tr_b16 v[186:187], v12 offset:5120
  ds_read_b64_tr_b16 v[188:189], v13 offset:4096
  ds_read_b64_tr_b16 v[190:191], v13 offset:5120
  v_lshlrev_b32 v220, 16, v33
  v_and_b32 v221, 0xffff0000, v33
  v_lshlrev_b32 v222, 16, v34
  v_and_b32 v223, 0xffff0000, v34
  v_lshlrev_b32 v224, 16, v35
  v_mfma_f32_32x32x16_bf16 v[80:95], v[168:171], v[136:139], v[80:95]
  buffer_load_dwordx4 v28, s[12:15], s59 offen offset:2048 lds
  v_and_b32 v225, 0xffff0000, v35
  v_lshlrev_b32 v226, 16, v36
  v_and_b32 v227, 0xffff0000, v36
  v_lshlrev_b32 v228, 16, v37
  v_and_b32 v229, 0xffff0000, v37
  v_mfma_f32_32x32x16_bf16 v[96:111], v[172:175], v[136:139], v[96:111]
  buffer_load_dwordx4 v29, s[12:15], s59 offen offset:3072 lds
  v_lshlrev_b32 v230, 16, v38
  v_and_b32 v231, 0xffff0000, v38
  v_lshlrev_b32 v232, 16, v39
  v_and_b32 v233, 0xffff0000, v39
  v_lshlrev_b32 v234, 16, v40
  v_mfma_f32_32x32x16_bf16 v[112:127], v[176:179], v[136:139], v[112:127]
  v_and_b32 v235, 0xffff0000, v40
  v_lshlrev_b32 v236, 16, v41
  v_and_b32 v237, 0xffff0000, v41
  v_mul_f32 v238, v52, v222
  v_mul_f32 v239, v52, v223
  s_waitcnt lgkmcnt(0)
  ds_read_b128 v[144:147], v8 offset:0
  ds_read_b64_tr_b16 v[164:165], v10 offset:8192
  ds_read_b64_tr_b16 v[166:167], v10 offset:9216
  v_mfma_f32_32x32x16_bf16 v[64:79], v[160:163], v[140:143], v[64:79]
  ds_read_b64_tr_b16 v[168:169], v11 offset:8192
  ds_read_b64_tr_b16 v[170:171], v11 offset:9216
  ds_read_b64_tr_b16 v[172:173], v12 offset:8192
  ds_read_b64_tr_b16 v[174:175], v12 offset:9216
  ds_read_b64_tr_b16 v[176:177], v13 offset:8192
  ds_read_b64_tr_b16 v[178:179], v13 offset:9216
  v_mul_f32 v240, v52, v224
  v_mul_f32 v241, v52, v225
  v_mul_f32 v242, v52, v226
  v_mul_f32 v243, v52, v227
  v_mul_f32 v244, v52, v228
  v_mfma_f32_32x32x16_bf16 v[80:95], v[180:183], v[140:143], v[80:95]
  s_add_u32 m0, s58, 81920
  s_mov_b32 s60, 1146880
  buffer_load_dwordx4 v4, s[24:27], s60 offen lds
  v_mul_f32 v245, v52, v229
  v_mul_f32 v246, v52, v230
  v_mul_f32 v247, v52, v231
  v_mul_f32 v248, v52, v232
  v_mul_f32 v249, v52, v233
  v_mfma_f32_32x32x16_bf16 v[96:111], v[184:187], v[140:143], v[96:111]
  buffer_load_dwordx4 v25, s[24:27], s60 offen offset:1024 lds
  v_mul_f32 v250, v52, v234
  v_mul_f32 v251, v52, v235
  v_mul_f32 v252, v52, v236
  v_mul_f32 v253, v52, v237
  v_fmac_f32 v238, v53, v221
  v_mfma_f32_32x32x16_bf16 v[112:127], v[188:191], v[140:143], v[112:127]
  v_fmac_f32 v239, v53, v222
  v_fmac_f32 v240, v53, v223
  v_fmac_f32 v241, v53, v224
  v_fmac_f32 v242, v53, v225
  v_fmac_f32 v243, v53, v226
  s_waitcnt lgkmcnt(0)
  ds_read_b128 v[128:131], v9 offset:0
  ds_read_b64_tr_b16 v[148:149], v10 offset:12288
  ds_read_b64_tr_b16 v[150:151], v10 offset:13312
  v_mfma_f32_32x32x16_bf16 v[64:79], v[164:167], v[144:147], v[64:79]
  ds_read_b64_tr_b16 v[180:181], v11 offset:12288
  ds_read_b64_tr_b16 v[182:183], v11 offset:13312
  ds_read_b64_tr_b16 v[184:185], v12 offset:12288
  ds_read_b64_tr_b16 v[186:187], v12 offset:13312
  ds_read_b64_tr_b16 v[188:189], v13 offset:12288
  ds_read_b64_tr_b16 v[190:191], v13 offset:13312
  v_fmac_f32 v244, v53, v227
  v_fmac_f32 v245, v53, v228
  v_fmac_f32 v246, v53, v229
  v_fmac_f32 v247, v53, v230
  v_fmac_f32 v248, v53, v231
  v_mfma_f32_32x32x16_bf16 v[80:95], v[168:171], v[144:147], v[80:95]
  buffer_load_dwordx4 v26, s[24:27], s60 offen offset:2048 lds
  v_fmac_f32 v249, v53, v232
  v_fmac_f32 v250, v53, v233
  v_fmac_f32 v251, v53, v234
  v_fmac_f32 v252, v53, v235
  v_fmac_f32 v253, v53, v236
  v_mfma_f32_32x32x16_bf16 v[96:111], v[172:175], v[144:147], v[96:111]
  buffer_load_dwordx4 v27, s[24:27], s60 offen offset:3072 lds
  v_fmac_f32 v238, v54, v220
  v_fmac_f32 v239, v54, v221
  v_fmac_f32 v240, v54, v222
  v_fmac_f32 v241, v54, v223
  v_fmac_f32 v242, v54, v224
  v_mfma_f32_32x32x16_bf16 v[112:127], v[176:179], v[144:147], v[112:127]
  v_fmac_f32 v243, v54, v225
  v_fmac_f32 v244, v54, v226
  v_fmac_f32 v245, v54, v227
  v_fmac_f32 v246, v54, v228
  v_fmac_f32 v247, v54, v229
  s_waitcnt lgkmcnt(0)
  s_waitcnt vmcnt(8)
  s_barrier
  ds_read_b128 v[132:135], v6 offset:32768
  ds_read_b64_tr_b16 v[152:153], v10 offset:32768
  ds_read_b64_tr_b16 v[154:155], v10 offset:33792
  v_mfma_f32_32x32x16_bf16 v[64:79], v[148:151], v[128:131], v[64:79]
  ds_read_b64_tr_b16 v[168:169], v11 offset:32768
  ds_read_b64_tr_b16 v[170:171], v11 offset:33792
  ds_read_b64_tr_b16 v[172:173], v12 offset:32768
  ds_read_b64_tr_b16 v[174:175], v12 offset:33792
  ds_read_b64_tr_b16 v[176:177], v13 offset:32768
  ds_read_b64_tr_b16 v[178:179], v13 offset:33792
  v_fmac_f32 v248, v54, v230
  v_fmac_f32 v249, v54, v231
  v_fmac_f32 v250, v54, v232
  v_fmac_f32 v251, v54, v233
  v_fmac_f32 v252, v54, v234
  v_mfma_f32_32x32x16_bf16 v[80:95], v[180:183], v[128:131], v[80:95]
  s_add_u32 m0, s58, 0
  s_mov_b32 s59, 768
  buffer_load_dwordx4 v2, s[12:15], s59 offen lds
  v_fmac_f32 v253, v54, v235
  v_fmac_f32 v238, v55, v219
  v_fmac_f32 v239, v55, v220
  v_fmac_f32 v240, v55, v221
  v_fmac_f32 v241, v55, v222
  v_mfma_f32_32x32x16_bf16 v[96:111], v[184:187], v[128:131], v[96:111]
  buffer_load_dwordx4 v3, s[12:15], s59 offen offset:1024 lds
  v_fmac_f32 v242, v55, v223
  v_fmac_f32 v243, v55, v224
  v_fmac_f32 v244, v55, v225
  v_fmac_f32 v245, v55, v226
  v_fmac_f32 v246, v55, v227
  v_mfma_f32_32x32x16_bf16 v[112:127], v[188:191], v[128:131], v[112:127]
  v_fmac_f32 v247, v55, v228
  v_fmac_f32 v248, v55, v229
  v_fmac_f32 v249, v55, v230
  v_fmac_f32 v250, v55, v231
  v_fmac_f32 v251, v55, v232
  s_waitcnt lgkmcnt(0)
  ds_read_b128 v[136:139], v7 offset:32768
  ds_read_b64_tr_b16 v[156:157], v10 offset:36864
  ds_read_b64_tr_b16 v[158:159], v10 offset:37888
  v_mfma_f32_32x32x16_bf16 v[64:79], v[152:155], v[132:135], v[64:79]
  ds_read_b64_tr_b16 v[180:181], v11 offset:36864
  ds_read_b64_tr_b16 v[182:183], v11 offset:37888
  ds_read_b64_tr_b16 v[184:185], v12 offset:36864
  ds_read_b64_tr_b16 v[186:187], v12 offset:37888
  ds_read_b64_tr_b16 v[188:189], v13 offset:36864
  ds_read_b64_tr_b16 v[190:191], v13 offset:37888
  v_fmac_f32 v252, v55, v233
  v_fmac_f32 v253, v55, v234
  v_lshlrev_b32 v218, 16, v42
  v_and_b32 v219, 0xffff0000, v42
  v_lshlrev_b32 v220, 16, v43
  v_mfma_f32_32x32x16_bf16 v[80:95], v[168:171], v[132:135], v[80:95]
  buffer_load_dwordx4 v28, s[12:15], s59 offen offset:2048 lds
  v_and_b32 v221, 0xffff0000, v43
  v_lshlrev_b32 v222, 16, v44
  v_and_b32 v223, 0xffff0000, v44
  v_lshlrev_b32 v224, 16, v45
  v_and_b32 v225, 0xffff0000, v45
  s_add_u32 s52, s4, 0
  s_and_b32 s52, s52, 3
  s_lshl_b32 s52, s52, 6
  v_add_u32 v61, s52, v24
  global_load_ushort v5, v61, s[48:49]
  v_mfma_f32_32x32x16_bf16 v[96:111], v[172:175], v[132:135], v[96:111]
  buffer_load_dwordx4 v29, s[12:15], s59 offen offset:3072 lds
  v_lshlrev_b32 v226, 16, v46
  v_and_b32 v227, 0xffff0000, v46
  v_lshlrev_b32 v228, 16, v47
  v_and_b32 v229, 0xffff0000, v47
  v_lshlrev_b32 v230, 16, v48
  s_add_u32 s52, s4, 1
  s_and_b32 s52, s52, 3
  s_lshl_b32 s52, s52, 6
  v_add_u32 v61, s52, v24
  global_load_ushort v57, v61, s[48:49]
  v_mfma_f32_32x32x16_bf16 v[112:127], v[176:179], v[132:135], v[112:127]
  v_and_b32 v231, 0xffff0000, v48
  v_lshlrev_b32 v232, 16, v49
  v_and_b32 v233, 0xffff0000, v49
  v_mul_f32 v238, v238, v218
  v_mul_f32 v239, v239, v219
  s_add_u32 s52, s4, 2
  s_and_b32 s52, s52, 3
  s_lshl_b32 s52, s52, 6
  v_add_u32 v61, s52, v24
  global_load_ushort v58, v61, s[48:49]
  s_add_u32 s52, s4, 3
  s_and_b32 s52, s52, 3
  s_lshl_b32 s52, s52, 6
  v_add_u32 v61, s52, v24
  global_load_ushort v59, v61, s[48:49]
  s_waitcnt lgkmcnt(0)
  ds_read_b128 v[140:143], v8 offset:32768
  ds_read_b64_tr_b16 v[160:161], v10 offset:40960
  ds_read_b64_tr_b16 v[162:163], v10 offset:41984
  v_mfma_f32_32x32x16_bf16 v[64:79], v[156:159], v[136:139], v[64:79]
  ds_read_b64_tr_b16 v[168:169], v11 offset:40960
  ds_read_b64_tr_b16 v[170:171], v11 offset:41984
  ds_read_b64_tr_b16 v[172:173], v12 offset:40960
  ds_read_b64_tr_b16 v[174:175], v12 offset:41984
  ds_read_b64_tr_b16 v[176:177], v13 offset:40960
  ds_read_b64_tr_b16 v[178:179], v13 offset:41984
  v_mul_f32 v240, v240, v220
  v_mul_f32 v241, v241, v221
  v_mul_f32 v242, v242, v222
  v_mul_f32 v243, v243, v223
  v_mul_f32 v244, v244, v224
  v_mfma_f32_32x32x16_bf16 v[80:95], v[180:183], v[136:139], v[80:95]
  s_add_u32 m0, s58, 16384
  s_mov_b32 s60, 1376256
  buffer_load_dwordx4 v4, s[24:27], s60 offen lds
  v_mul_f32 v245, v245, v225
  v_mul_f32 v246, v246, v226
  v_mul_f32 v247, v247, v227
  v_mul_f32 v248, v248, v228
  v_mul_f32 v249, v249, v229
  v_mfma_f32_32x32x16_bf16 v[96:111], v[184:187], v[136:139], v[96:111]
  buffer_load_dwordx4 v25, s[24:27], s60 offen offset:1024 lds
  v_mul_f32 v250, v250, v230
  v_mul_f32 v251, v251, v231
  v_mul_f32 v252, v252, v232
  v_mul_f32 v253, v253, v233
  v_cvt_pk_bf16_f32 v32, v253, v252
  v_mfma_f32_32x32x16_bf16 v[112:127], v[188:191], v[136:139], v[112:127]
  v_cvt_pk_bf16_f32 v33, v251, v250
  v_cvt_pk_bf16_f32 v34, v249, v248
  v_cvt_pk_bf16_f32 v35, v247, v246
  v_cvt_pk_bf16_f32 v36, v245, v244
  v_cvt_pk_bf16_f32 v37, v243, v242
  s_waitcnt lgkmcnt(0)
  ds_read_b128 v[144:147], v9 offset:32768
  ds_read_b64_tr_b16 v[164:165], v10 offset:45056
  ds_read_b64_tr_b16 v[166:167], v10 offset:46080
  v_mfma_f32_32x32x16_bf16 v[64:79], v[160:163], v[140:143], v[64:79]
  ds_read_b64_tr_b16 v[180:181], v11 offset:45056
  ds_read_b64_tr_b16 v[182:183], v11 offset:46080
  ds_read_b64_tr_b16 v[184:185], v12 offset:45056
  ds_read_b64_tr_b16 v[186:187], v12 offset:46080
  ds_read_b64_tr_b16 v[188:189], v13 offset:45056
  ds_read_b64_tr_b16 v[190:191], v13 offset:46080
  v_cvt_pk_bf16_f32 v38, v241, v240
  v_cvt_pk_bf16_f32 v39, v239, v238
  s_lshl_b32 s52, s4, 11
  s_add_u32 s52, s52, 115712
  v_lshl_add_u32 v16, v16, 7, s52
  v_lshl_add_u32 v20, v1, 4, s52
  v_lshl_add_u32 v18, v17, 4, v16
  v_xor_b32 v17, 1, v17
  v_mfma_f32_32x32x16_bf16 v[80:95], v[168:171], v[140:143], v[80:95]
  buffer_load_dwordx4 v26, s[24:27], s60 offen offset:2048 lds
  v_lshl_add_u32 v19, v17, 4, v16
  ds_write_b128 v18, v[32:35]
  ds_write_b128 v19, v[36:39]
  v_lshrrev_b32 v21, 3, v1
  v_and_b32 v22, 7, v1
  v_mfma_f32_32x32x16_bf16 v[96:111], v[172:175], v[140:143], v[96:111]
  buffer_load_dwordx4 v27, s[24:27], s60 offen offset:3072 lds
  v_xor_b32 v22, v22, v21
  s_lshl_b32 s52, s6, 6
  s_lshl_b32 s53, s4, 4
  s_add_u32 s52, s52, s53
  v_add_u32 v21, s52, v21
  v_lshlrev_b32 v21, 12, v21
  v_lshl_add_u32 v21, v22, 4, v21
  s_lshl_b32 s52, s5, 7
  s_sub_u32 s52, 8392576, s52
  v_add_u32 v21, s52, v21
  v_mfma_f32_32x32x16_bf16 v[112:127], v[176:179], v[140:143], v[112:127]
  v_add_u32 v22, 32768, v21
  s_waitcnt lgkmcnt(0)
  ds_read_b128 v[40:43], v20
  ds_read_b128 v[44:47], v20 offset:1024
  s_waitcnt vmcnt(12)
  s_barrier
  v_add_u32 v6, 0x10000, v6
  v_add_u32 v7, 0x10000, v7
  v_add_u32 v8, 0x10000, v8
  v_add_u32 v9, 0x10000, v9
  v_add_u32 v10, 0x10000, v10
  v_add_u32 v11, 0x10000, v11
  v_add_u32 v12, 0x10000, v12
  v_add_u32 v13, 0x10000, v13
  ds_read_b128 v[128:131], v6 offset:0
  ds_read_b64_tr_b16 v[148:149], v10 offset:0
  ds_read_b64_tr_b16 v[150:151], v10 offset:1024
  v_mfma_f32_32x32x16_bf16 v[64:79], v[164:167], v[144:147], v[64:79]
  ds_read_b64_tr_b16 v[168:169], v11 offset:0
  ds_read_b64_tr_b16 v[170:171], v11 offset:1024
  ds_read_b64_tr_b16 v[172:173], v12 offset:0
  ds_read_b64_tr_b16 v[174:175], v12 offset:1024
  ds_read_b64_tr_b16 v[176:177], v13 offset:0
  ds_read_b64_tr_b16 v[178:179], v13 offset:1024
  v_mfma_f32_32x32x16_bf16 v[80:95], v[180:183], v[144:147], v[80:95]
  v_mfma_f32_32x32x16_bf16 v[96:111], v[184:187], v[144:147], v[96:111]
  v_mfma_f32_32x32x16_bf16 v[112:127], v[188:191], v[144:147], v[112:127]
  s_waitcnt lgkmcnt(9)
  buffer_store_dwordx4 v[40:43], v21, s[28:31], 0 offen sc1
  buffer_store_dwordx4 v[44:47], v22, s[28:31], 0 offen sc1
  s_waitcnt lgkmcnt(0)
  ds_read_b128 v[132:135], v7 offset:0
  ds_read_b64_tr_b16 v[152:153], v10 offset:4096
  ds_read_b64_tr_b16 v[154:155], v10 offset:5120
  v_mfma_f32_32x32x16_bf16 v[64:79], v[148:151], v[128:131], v[64:79]
  ds_read_b64_tr_b16 v[180:181], v11 offset:4096
  ds_read_b64_tr_b16 v[182:183], v11 offset:5120
  ds_read_b64_tr_b16 v[184:185], v12 offset:4096
  ds_read_b64_tr_b16 v[186:187], v12 offset:5120
  ds_read_b64_tr_b16 v[188:189], v13 offset:4096
  ds_read_b64_tr_b16 v[190:191], v13 offset:5120
  v_mfma_f32_32x32x16_bf16 v[80:95], v[168:171], v[128:131], v[80:95]
  s_lshl_b32 s52, s7, 7
  s_lshl_b32 s53, s4, 5
  s_add_u32 s52, s52, s53
  s_lshl_b32 s52, s52, 3
  s_add_u32 s52, s52, 12615680
  v_and_b32 v52, 31, v1
  v_lshl_add_u32 v52, v52, 3, s52
  buffer_load_dwordx2 v[208:209], v52, s[28:31], 0 offen sc1
  v_lshrrev_b32 v14, 3, v1
  s_mul_i32 s52, s4, 448
  v_add_u32 v14, s52, v14
  v_mfma_f32_32x32x16_bf16 v[96:111], v[172:175], v[128:131], v[96:111]
  v_mul_u32_u24 v14, 896, v14
  v_and_b32 v15, 7, v1
  v_bfe_u32 v16, v1, 4, 1
  v_lshlrev_b32 v16, 2, v16
  v_xor_b32 v15, v15, v16
  v_lshl_add_u32 v14, v15, 4, v14
  v_mfma_f32_32x32x16_bf16 v[112:127], v[176:179], v[128:131], v[112:127]
  s_lshl_b32 s52, s6, 7
  v_add_u32 v32, s52, v14
  s_mul_i32 s58, s4, 10240
  s_add_u32 s58, s58, 100352
  s_mul_i32 s63, s4, 12288
  v_bfe_u32 v14, v1, 2, 2
  v_lshrrev_b32 v15, 5, v1
  v_lshl_add_u32 v15, v15, 2, v14
  v_lshlrev_b32 v15, 7, v15
  v_bfe_u32 v16, v1, 4, 1
  v_lshlrev_b32 v16, 5, v16
  v_and_b32 v17, 3, v1
  v_lshl_add_u32 v16, v17, 3, v16
  v_add3_u32 v15, v15, v16, s58
  s_waitcnt lgkmcnt(0)
  ds_read_b128 v[136:139], v8 offset:0
  ds_read_b64_tr_b16 v[156:157], v10 offset:8192
  ds_read_b64_tr_b16 v[158:159], v10 offset:9216
  v_mfma_f32_32x32x16_bf16 v[64:79], v[152:155], v[132:135], v[64:79]
  ds_read_b64_tr_b16 v[168:169], v11 offset:8192
  ds_read_b64_tr_b16 v[170:171], v11 offset:9216
  ds_read_b64_tr_b16 v[172:173], v12 offset:8192
  ds_read_b64_tr_b16 v[174:175], v12 offset:9216
  ds_read_b64_tr_b16 v[176:177], v13 offset:8192
  ds_read_b64_tr_b16 v[178:179], v13 offset:9216
  v_mfma_f32_32x32x16_bf16 v[80:95], v[180:183], v[132:135], v[80:95]
  v_lshrrev_b32 v14, 1, v14
  s_and_b32 s52, s4, 1
  v_xor_b32 v14, s52, v14
  v_lshl_add_u32 v33, v14, 6, v15
  v_xor_b32 v14, 1, v14
  v_lshl_add_u32 v34, v14, 6, v15
  v_mfma_f32_32x32x16_bf16 v[96:111], v[184:187], v[132:135], v[96:111]
  s_sub_u32 s52, s63, s58
  v_add_u32 v35, s52, v33
  v_add_u32 v43, s52, v34
  v_add_u32 v60, 6144, v32
  s_add_u32 m0, s58, 0
  s_mul_i32 s73, s3, 57344
  s_add_u32 s57, s73, 0
  buffer_load_dwordx4 v32, s[32:35], s57 offen lds
  buffer_load_dwordx4 v60, s[32:35], s57 offen offset:1024 lds
  v_mfma_f32_32x32x16_bf16 v[112:127], v[188:191], v[132:135], v[112:127]
  s_add_u32 m0, s58, 2048
  s_add_u32 s57, s73, 14336
  buffer_load_dwordx4 v32, s[32:35], s57 offen lds
  buffer_load_dwordx4 v60, s[32:35], s57 offen offset:1024 lds
  s_waitcnt lgkmcnt(0)
  ds_read_b128 v[140:143], v9 offset:0
  ds_read_b64_tr_b16 v[160:161], v10 offset:12288
  ds_read_b64_tr_b16 v[162:163], v10 offset:13312
  v_mfma_f32_32x32x16_bf16 v[64:79], v[156:159], v[136:139], v[64:79]
  ds_read_b64_tr_b16 v[180:181], v11 offset:12288
  ds_read_b64_tr_b16 v[182:183], v11 offset:13312
  ds_read_b64_tr_b16 v[184:185], v12 offset:12288
  ds_read_b64_tr_b16 v[186:187], v12 offset:13312
  ds_read_b64_tr_b16 v[188:189], v13 offset:12288
  ds_read_b64_tr_b16 v[190:191], v13 offset:13312
  v_mfma_f32_32x32x16_bf16 v[80:95], v[168:171], v[136:139], v[80:95]
  s_add_u32 m0, s58, 4096
  s_add_u32 s57, s73, 28672
  buffer_load_dwordx4 v32, s[32:35], s57 offen lds
  buffer_load_dwordx4 v60, s[32:35], s57 offen offset:1024 lds
  v_mfma_f32_32x32x16_bf16 v[96:111], v[172:175], v[136:139], v[96:111]
  v_mfma_f32_32x32x16_bf16 v[112:127], v[176:179], v[136:139], v[112:127]
  v_lshrrev_b32 v22, 2, v1
  s_lshr_b32 s52, s4, 1
  s_lshl_b32 s52, s52, 5
  s_lshl_b32 s53, s5, 6
  s_add_u32 s52, s52, s53
  v_add_u32 v23, s52, v22
  v_mul_u32_u24 v23, 896, v23
  v_bfe_u32 v24, v1, 3, 2
  v_and_b32 v25, 3, v1
  v_xor_b32 v24, v24, v25
  s_and_b32 s52, s4, 1
  s_lshl_b32 s52, s52, 6
  s_lshl_b32 s53, s6, 7
  s_add_u32 s52, s52, s53
  v_lshl_add_u32 v23, v24, 4, v23
  v_add_u32 v36, s52, v23
  v_add_u32 v37, 14336, v36
  s_waitcnt lgkmcnt(0)
  s_waitcnt vmcnt(9)
  s_barrier
  v_add_u32 v6, 0xffff0000, v6
  v_add_u32 v7, 0xffff0000, v7
  v_add_u32 v8, 0xffff0000, v8
  v_add_u32 v9, 0xffff0000, v9
  v_add_u32 v10, 0xffff0000, v10
  v_add_u32 v11, 0xffff0000, v11
  v_add_u32 v12, 0xffff0000, v12
  v_add_u32 v13, 0xffff0000, v13
  ds_read_b128 v[144:147], v6 offset:0
  ds_read_b64_tr_b16 v[164:165], v10 offset:0
  ds_read_b64_tr_b16 v[166:167], v10 offset:1024
  v_mfma_f32_32x32x16_bf16 v[64:79], v[160:163], v[140:143], v[64:79]
  ds_read_b64_tr_b16 v[168:169], v11 offset:0
  ds_read_b64_tr_b16 v[170:171], v11 offset:1024
  ds_read_b64_tr_b16 v[172:173], v12 offset:0
  ds_read_b64_tr_b16 v[174:175], v12 offset:1024
  ds_read_b64_tr_b16 v[176:177], v13 offset:0
  ds_read_b64_tr_b16 v[178:179], v13 offset:1024
  v_mfma_f32_32x32x16_bf16 v[80:95], v[180:183], v[140:143], v[80:95]
  s_lshr_b32 s52, s4, 1
  s_lshl_b32 s53, s5, 1
  s_add_u32 s54, s53, s52
  s_xor_b32 s52, s52, 1
  s_add_u32 s53, s53, s52
  s_mul_i32 s54, s54, 131072
  s_mul_i32 s53, s53, 131072
  s_mul_i32 s52, s4, 28672
  s_add_u32 s54, s54, s52
  s_add_u32 s53, s53, s52
  v_lshlrev_b32 v22, 4, v1
  v_add_u32 v46, s54, v22
  v_add_u32 v47, s53, v22
  s_add_u32 s76, s4, 0
  s_and_b32 s76, s76, 3
  s_lshl_b32 s76, s76, 11
  s_add_u32 s77, s4, 1
  s_and_b32 s77, s77, 3
  s_lshl_b32 s77, s77, 11
  s_add_u32 s78, s4, 2
  s_and_b32 s78, s78, 3
  s_lshl_b32 s78, s78, 11
  s_add_u32 s79, s4, 3
  s_and_b32 s79, s79, 3
  s_lshl_b32 s79, s79, 11
  v_mfma_f32_32x32x16_bf16 v[96:111], v[184:187], v[140:143], v[96:111]
  s_lshl_b32 s52, s8, 10
  s_add_u32 s52, s52, 12632064
  v_and_b32 v53, 31, v1
  v_lshl_add_u32 v53, v53, 3, s52
  s_lshr_b32 s56, s76, 3
  buffer_load_dwordx2 v[236:237], v53, s[28:31], s56 offen sc1
  v_mfma_f32_32x32x16_bf16 v[112:127], v[188:191], v[140:143], v[112:127]
  s_lshr_b32 s56, s77, 3
  buffer_load_dwordx2 v[240:241], v53, s[28:31], s56 offen sc1
  s_lshr_b32 s56, s78, 3
  buffer_load_dwordx2 v[244:245], v53, s[28:31], s56 offen sc1
  s_waitcnt lgkmcnt(0)
  ds_read_b128 v[128:131], v7 offset:0
  ds_read_b64_tr_b16 v[148:149], v10 offset:4096
  ds_read_b64_tr_b16 v[150:151], v10 offset:5120
  v_mfma_f32_32x32x16_bf16 v[64:79], v[164:167], v[144:147], v[64:79]
  ds_read_b64_tr_b16 v[180:181], v11 offset:4096
  ds_read_b64_tr_b16 v[182:183], v11 offset:5120
  ds_read_b64_tr_b16 v[184:185], v12 offset:4096
  ds_read_b64_tr_b16 v[186:187], v12 offset:5120
  ds_read_b64_tr_b16 v[188:189], v13 offset:4096
  ds_read_b64_tr_b16 v[190:191], v13 offset:5120
  v_mfma_f32_32x32x16_bf16 v[80:95], v[168:171], v[144:147], v[80:95]
  s_lshr_b32 s56, s79, 3
  buffer_load_dwordx2 v[248:249], v53, s[28:31], s56 offen sc1
  v_mfma_f32_32x32x16_bf16 v[96:111], v[172:175], v[144:147], v[96:111]
  s_lshr_b32 s94, s4, 1
  s_and_b32 s96, s4, 1
  s_lshl_b32 s95, s2, 1
  s_add_u32 s95, s95, s94
  s_mul_i32 s97, s94, 13056
  s_add_u32 s97, s97, 49152
  v_mfma_f32_32x32x16_bf16 v[112:127], v[176:179], v[144:147], v[112:127]
  s_add_u32 m0, s58, 6144
  s_add_u32 s57, s73, 43008
  buffer_load_dwordx4 v32, s[32:35], s57 offen lds
  buffer_load_dwordx4 v60, s[32:35], s57 offen offset:1024 lds
  s_waitcnt lgkmcnt(0)
  ds_read_b128 v[132:135], v8 offset:0
  ds_read_b64_tr_b16 v[152:153], v10 offset:8192
  ds_read_b64_tr_b16 v[154:155], v10 offset:9216
  v_mfma_f32_32x32x16_bf16 v[64:79], v[148:151], v[128:131], v[64:79]
  ds_read_b64_tr_b16 v[168:169], v11 offset:8192
  ds_read_b64_tr_b16 v[170:171], v11 offset:9216
  ds_read_b64_tr_b16 v[172:173], v12 offset:8192
  ds_read_b64_tr_b16 v[174:175], v12 offset:9216
  ds_read_b64_tr_b16 v[176:177], v13 offset:8192
  ds_read_b64_tr_b16 v[178:179], v13 offset:9216
  v_mfma_f32_32x32x16_bf16 v[80:95], v[180:183], v[128:131], v[80:95]
  s_add_u32 m0, s58, 8192
  s_mul_i32 s73, s67, 57344
  s_add_u32 s57, s73, 0
  buffer_load_dwordx4 v32, s[32:35], s57 offen lds
  buffer_load_dwordx4 v60, s[32:35], s57 offen offset:1024 lds
  v_mfma_f32_32x32x16_bf16 v[96:111], v[184:187], v[128:131], v[96:111]
  s_lshl_b32 s52, s95, 12
  s_lshl_b32 s53, s96, 11
  s_add_u32 s52, s52, s53
  v_lshl_add_u32 v220, v1, 4, s52
  s_add_u32 s75, s97, s53
  v_mfma_f32_32x32x16_bf16 v[112:127], v[188:191], v[128:131], v[112:127]
  v_add_u32 v221, 2, v220
  v_add_u32 v54, 8388608, v220
  s_add_u32 m0, s75, 32
  s_nop 0
  buffer_load_dwordx4 v220, s[36:39], 0 offen lds
  buffer_load_dwordx4 v220, s[36:39], 0 offen offset:1024 lds
  s_waitcnt lgkmcnt(0)
  ds_read_b128 v[136:139], v9 offset:0
  ds_read_b64_tr_b16 v[156:157], v10 offset:12288
  ds_read_b64_tr_b16 v[158:159], v10 offset:13312
  v_mfma_f32_32x32x16_bf16 v[64:79], v[152:155], v[132:135], v[64:79]
  ds_read_b64_tr_b16 v[180:181], v11 offset:12288
  ds_read_b64_tr_b16 v[182:183], v11 offset:13312
  ds_read_b64_tr_b16 v[184:185], v12 offset:12288
  ds_read_b64_tr_b16 v[186:187], v12 offset:13312
  ds_read_b64_tr_b16 v[188:189], v13 offset:12288
  ds_read_b64_tr_b16 v[190:191], v13 offset:13312
  v_mfma_f32_32x32x16_bf16 v[80:95], v[168:171], v[132:135], v[80:95]
  s_add_u32 m0, s75, 4192
  s_nop 0
  buffer_load_dwordx4 v221, s[36:39], 0 offen lds
  v_mfma_f32_32x32x16_bf16 v[96:111], v[172:175], v[132:135], v[96:111]
  buffer_load_dwordx4 v221, s[36:39], 0 offen offset:1024 lds
  v_mfma_f32_32x32x16_bf16 v[112:127], v[176:179], v[132:135], v[112:127]
  s_lshl_b32 s52, s95, 1
  v_mov_b32 v228, s52
  global_load_ushort v55, v228, s[46:47]
  s_lshl_b32 s52, s95, 12
  v_mov_b32 v228, s52
  buffer_load_ushort v222, v228, s[36:39], 0 offen
  s_waitcnt lgkmcnt(0)
  v_mfma_f32_32x32x16_bf16 v[64:79], v[156:159], v[136:139], v[64:79]
  v_mfma_f32_32x32x16_bf16 v[80:95], v[180:183], v[136:139], v[80:95]
  v_mfma_f32_32x32x16_bf16 v[96:111], v[184:187], v[136:139], v[96:111]
  s_waitcnt vmcnt(18)
  ds_read_b64_tr_b16 a[0:1], v33 offset:0
  ds_read_b64_tr_b16 a[2:3], v33 offset:1024
  ds_read_b64_tr_b16 a[4:5], v34 offset:0
  ds_read_b64_tr_b16 a[6:7], v34 offset:1024
  v_mfma_f32_32x32x16_bf16 v[112:127], v[188:191], v[136:139], v[112:127]
  s_waitcnt vmcnt(16)
  ds_read_b64_tr_b16 a[8:9], v33 offset:2048
  ds_read_b64_tr_b16 a[10:11], v33 offset:3072
  ds_read_b64_tr_b16 a[12:13], v34 offset:2048
  ds_read_b64_tr_b16 a[14:15], v34 offset:3072
  s_lshl_b32 s52, s6, 9
  s_lshl_b32 s53, s5, 4
  s_add_u32 s52, s52, s53
  s_lshl_b32 s53, s4, 2
  s_add_u32 s52, s52, s53
  s_add_u32 s52, s52, 12587008
  v_mov_b32 v30, s52
  v_mov_b32 v31, s50
  s_mov_b64 exec, 1
  buffer_store_dword v31, v30, s[28:31], 0 offen sc1
  s_mov_b64 exec, -1
  s_waitcnt vmcnt(11)
  s_mov_b32 s62, 0
L_chk_sg:
  v_xor_b32 v192, s50, v209
  v_xor_b32 v193, s50, v237
  v_or_b32 v192, v192, v193
  v_xor_b32 v193, s50, v241
  v_or_b32 v192, v192, v193
  v_xor_b32 v193, s50, v245
  v_or_b32 v192, v192, v193
  v_xor_b32 v193, s50, v249
  v_or_b32 v192, v192, v193
  v_cmp_ne_u32 vcc, 0, v192
  s_nop 4
  s_cbranch_vccz L_ok_sg
  s_add_u32 s62, s62, 1
  s_cmp_gt_u32 s62, 65536
  s_cbranch_scc1 L_ok_sg
  s_sleep 2
  buffer_load_dwordx2 v[208:209], v52, s[28:31], 0 offen sc1
  s_lshr_b32 s56, s76, 3
  buffer_load_dwordx2 v[236:237], v53, s[28:31], s56 offen sc1
  s_lshr_b32 s56, s77, 3
  buffer_load_dwordx2 v[240:241], v53, s[28:31], s56 offen sc1
  s_lshr_b32 s56, s78, 3
  buffer_load_dwordx2 v[244:245], v53, s[28:31], s56 offen sc1
  s_lshr_b32 s56, s79, 3
  buffer_load_dwordx2 v[248:249], v53, s[28:31], s56 offen sc1
  s_waitcnt vmcnt(0)
  s_branch L_chk_sg
        L_ok_sg:
  v_and_b32 v196, 0xffff0000, v208
  v_and_b32 v197, 0xffff, v208
  v_rcp_f32 v198, v196
  v_lshl_or_b32 v197, v197, 16, v197
  v_cmp_gt_u32 s[84:85], 32, v1
  v_lshrrev_b32 v199, 16, v208
  v_xor_b32 v197, 0x80008000, v197
  v_mov_b32 v232, 0
  v_mov_b32 v233, 0
  v_cndmask_b32 v230, 0, v197, s[84:85]
  v_cndmask_b32 v231, 0, v199, s[84:85]
  v_mul_f32 v48, 0x3fb8aa3b, v198
  v_mov_b32 v237, v5
  v_mov_b32 v238, 0
  v_mov_b32 v239, 0
  v_mov_b32 v241, v57
  v_mov_b32 v242, 0
  v_mov_b32 v243, 0
  v_mov_b32 v245, v58
  v_mov_b32 v246, 0
  v_mov_b32 v247, 0
  v_mov_b32 v249, v59
  v_mov_b32 v250, 0
  v_mov_b32 v251, 0
  v_mfma_f32_32x32x16_bf16 v[64:79], v[236:239], v[230:233], v[64:79]
  v_mfma_f32_32x32x16_bf16 v[80:95], v[240:243], v[230:233], v[80:95]
  v_mfma_f32_32x32x16_bf16 v[96:111], v[244:247], v[230:233], v[96:111]
  v_mfma_f32_32x32x16_bf16 v[112:127], v[248:251], v[230:233], v[112:127]
  s_waitcnt lgkmcnt(0)
  s_barrier
  s_add_u32 m0, s63, 0
  s_add_u32 s57, s73, 14336
  buffer_load_dwordx4 v32, s[32:35], s57 offen lds
  buffer_load_dwordx4 v60, s[32:35], s57 offen offset:1024 lds
  s_add_u32 m0, s63, 2048
  s_add_u32 s57, s73, 28672
  buffer_load_dwordx4 v32, s[32:35], s57 offen lds
  buffer_load_dwordx4 v60, s[32:35], s57 offen offset:1024 lds
  s_lshl_b32 s52, s7, 2
  s_add_u32 s52, s52, s4
  s_mul_i32 s52, s52, 131072
  s_lshl_b32 s53, s8, 13
  s_add_u32 s52, s52, s53
  v_lshlrev_b32 v18, 4, v1
  v_add_u32 v18, s52, v18
  v_mov_b32 v58, 1.0
  v_mov_b32 v59, 1.0
  v_mov_b32 v49, v48
  v_pk_mul_f32 v[64:65], v[64:65], v[48:49]
  v_pk_mul_f32 v[66:67], v[66:67], v[48:49]
  v_pk_mul_f32 v[68:69], v[68:69], v[48:49]
  v_pk_mul_f32 v[70:71], v[70:71], v[48:49]
  v_pk_mul_f32 v[72:73], v[72:73], v[48:49]
  v_pk_mul_f32 v[74:75], v[74:75], v[48:49]
  v_pk_mul_f32 v[76:77], v[76:77], v[48:49]
  s_add_u32 m0, s63, 4096
  s_add_u32 s57, s73, 43008
  buffer_load_dwordx4 v32, s[32:35], s57 offen lds
  v_pk_mul_f32 v[78:79], v[78:79], v[48:49]
  v_exp_f32 v168, v64
  v_exp_f32 v169, v65
  v_exp_f32 v170, v66
  v_exp_f32 v171, v67
  v_exp_f32 v172, v68
  v_exp_f32 v173, v69
  buffer_load_dwordx4 v60, s[32:35], s57 offen offset:1024 lds
  v_exp_f32 v174, v70
  v_exp_f32 v175, v71
  v_exp_f32 v176, v72
  v_exp_f32 v177, v73
  v_exp_f32 v178, v74
  v_exp_f32 v179, v75
  v_exp_f32 v180, v76
  v_exp_f32 v181, v77
  s_add_u32 m0, s63, 6144
  s_mul_i32 s73, s68, 57344
  s_add_u32 s57, s73, 0
  buffer_load_dwordx4 v32, s[32:35], s57 offen lds
  v_exp_f32 v182, v78
  v_exp_f32 v183, v79
  v_pk_add_f32 v[168:169], v[168:169], v[58:59]
  v_pk_add_f32 v[170:171], v[170:171], v[58:59]
  v_pk_add_f32 v[172:173], v[172:173], v[58:59]
  v_pk_add_f32 v[174:175], v[174:175], v[58:59]
  v_pk_add_f32 v[176:177], v[176:177], v[58:59]
  v_pk_add_f32 v[178:179], v[178:179], v[58:59]
  buffer_load_dwordx4 v60, s[32:35], s57 offen offset:1024 lds
  v_pk_add_f32 v[180:181], v[180:181], v[58:59]
  v_pk_add_f32 v[182:183], v[182:183], v[58:59]
  v_pk_fma_f32 v[168:169], v[168:169], v[168:169], v[58:59]
  v_pk_fma_f32 v[170:171], v[170:171], v[170:171], v[58:59]
  v_pk_fma_f32 v[172:173], v[172:173], v[172:173], v[58:59]
  v_pk_fma_f32 v[174:175], v[174:175], v[174:175], v[58:59]
  v_pk_fma_f32 v[176:177], v[176:177], v[176:177], v[58:59]
  v_pk_fma_f32 v[178:179], v[178:179], v[178:179], v[58:59]
  s_add_u32 m0, s63, 8192
  s_add_u32 s57, s73, 14336
  buffer_load_dwordx4 v32, s[32:35], s57 offen lds
  v_pk_fma_f32 v[180:181], v[180:181], v[180:181], v[58:59]
  v_pk_fma_f32 v[182:183], v[182:183], v[182:183], v[58:59]
  v_rcp_f32_e64 v168, v168 mul:2
  v_rcp_f32_e64 v169, v169 mul:2
  v_rcp_f32_e64 v170, v170 mul:2
  v_rcp_f32_e64 v171, v171 mul:2
  v_rcp_f32_e64 v172, v172 mul:2
  v_rcp_f32_e64 v173, v173 mul:2
  buffer_load_dwordx4 v60, s[32:35], s57 offen offset:1024 lds
  v_rcp_f32_e64 v174, v174 mul:2
  v_rcp_f32_e64 v175, v175 mul:2
  v_rcp_f32_e64 v176, v176 mul:2
  v_rcp_f32_e64 v177, v177 mul:2
  v_rcp_f32_e64 v178, v178 mul:2
  v_rcp_f32_e64 v179, v179 mul:2
  v_rcp_f32_e64 v180, v180 mul:2
  v_rcp_f32_e64 v181, v181 mul:2
  s_add_u32 m0, s63, 10240
  s_add_u32 s57, s73, 28672
  buffer_load_dwordx4 v32, s[32:35], s57 offen lds
  v_rcp_f32_e64 v182, v182 mul:2
  v_rcp_f32_e64 v183, v183 mul:2
  v_pk_fma_f32 v[168:169], v[64:65], v[168:169], v[64:65] neg_lo:[1,0,0] neg_hi:[1,0,0]
  v_pk_fma_f32 v[170:171], v[66:67], v[170:171], v[66:67] neg_lo:[1,0,0] neg_hi:[1,0,0]
  v_pk_fma_f32 v[172:173], v[68:69], v[172:173], v[68:69] neg_lo:[1,0,0] neg_hi:[1,0,0]
  v_pk_fma_f32 v[174:175], v[70:71], v[174:175], v[70:71] neg_lo:[1,0,0] neg_hi:[1,0,0]
  v_pk_fma_f32 v[176:177], v[72:73], v[176:177], v[72:73] neg_lo:[1,0,0] neg_hi:[1,0,0]
  v_pk_fma_f32 v[178:179], v[74:75], v[178:179], v[74:75] neg_lo:[1,0,0] neg_hi:[1,0,0]
  buffer_load_dwordx4 v60, s[32:35], s57 offen offset:1024 lds
  v_pk_fma_f32 v[180:181], v[76:77], v[180:181], v[76:77] neg_lo:[1,0,0] neg_hi:[1,0,0]
  v_pk_fma_f32 v[182:183], v[78:79], v[182:183], v[78:79] neg_lo:[1,0,0] neg_hi:[1,0,0]
  v_cvt_pk_bf16_f32 v184, v168, v169
  v_cvt_pk_bf16_f32 v185, v170, v171
  v_cvt_pk_bf16_f32 v186, v172, v173
  v_cvt_pk_bf16_f32 v187, v174, v175
  v_cvt_pk_bf16_f32 v188, v176, v177
  v_cvt_pk_bf16_f32 v189, v178, v179
  v_cvt_pk_bf16_f32 v190, v180, v181
  v_cvt_pk_bf16_f32 v191, v182, v183
  buffer_store_dwordx4 v[184:187], v18, s[28:31], s76 offen sc1
  v_pk_mul_f32 v[80:81], v[80:81], v[48:49]
  v_pk_mul_f32 v[82:83], v[82:83], v[48:49]
  v_pk_mul_f32 v[84:85], v[84:85], v[48:49]
  v_pk_mul_f32 v[86:87], v[86:87], v[48:49]
  v_pk_mul_f32 v[88:89], v[88:89], v[48:49]
  v_pk_mul_f32 v[90:91], v[90:91], v[48:49]
  v_pk_mul_f32 v[92:93], v[92:93], v[48:49]
  v_pk_mul_f32 v[94:95], v[94:95], v[48:49]
  buffer_store_dwordx4 v[188:191], v18, s[28:31], s76 offen offset:1024 sc1
  v_exp_f32 v168, v80
  v_exp_f32 v169, v81
  v_exp_f32 v170, v82
  v_exp_f32 v171, v83
  v_exp_f32 v172, v84
  v_exp_f32 v173, v85
  v_exp_f32 v174, v86
  v_exp_f32 v175, v87
  v_exp_f32 v176, v88
  v_exp_f32 v177, v89
  s_lshl_b32 s52, s5, 6
  s_lshr_b32 s53, s4, 1
  s_lshl_b32 s53, s53, 5
  s_add_u32 s52, s52, s53
  s_lshl_b32 s52, s52, 2
  s_add_u32 s52, s52, 6307840
  s_lshl_b32 s52, s52, 1
  v_and_b32 v45, 31, v1
  v_lshl_add_u32 v45, v45, 3, s52
  buffer_load_dword v44, v45, s[28:31], 0 offen sc1
  v_exp_f32 v178, v90
  v_exp_f32 v179, v91
  v_exp_f32 v180, v92
  v_exp_f32 v181, v93
  v_exp_f32 v182, v94
  v_exp_f32 v183, v95
  v_pk_add_f32 v[168:169], v[168:169], v[58:59]
  v_pk_add_f32 v[170:171], v[170:171], v[58:59]
  v_pk_add_f32 v[172:173], v[172:173], v[58:59]
  v_pk_add_f32 v[174:175], v[174:175], v[58:59]
  v_pk_add_f32 v[176:177], v[176:177], v[58:59]
  v_pk_add_f32 v[178:179], v[178:179], v[58:59]
  v_pk_add_f32 v[180:181], v[180:181], v[58:59]
  v_pk_add_f32 v[182:183], v[182:183], v[58:59]
  v_pk_fma_f32 v[168:169], v[168:169], v[168:169], v[58:59]
  v_pk_fma_f32 v[170:171], v[170:171], v[170:171], v[58:59]
  v_pk_fma_f32 v[172:173], v[172:173], v[172:173], v[58:59]
  v_pk_fma_f32 v[174:175], v[174:175], v[174:175], v[58:59]
  v_pk_fma_f32 v[176:177], v[176:177], v[176:177], v[58:59]
  v_pk_fma_f32 v[178:179], v[178:179], v[178:179], v[58:59]
  v_pk_fma_f32 v[180:181], v[180:181], v[180:181], v[58:59]
  v_pk_fma_f32 v[182:183], v[182:183], v[182:183], v[58:59]
  v_rcp_f32_e64 v168, v168 mul:2
  v_rcp_f32_e64 v169, v169 mul:2
  v_rcp_f32_e64 v170, v170 mul:2
  v_rcp_f32_e64 v171, v171 mul:2
  v_rcp_f32_e64 v172, v172 mul:2
  v_rcp_f32_e64 v173, v173 mul:2
  v_rcp_f32_e64 v174, v174 mul:2
  v_rcp_f32_e64 v175, v175 mul:2
  v_rcp_f32_e64 v176, v176 mul:2
  v_rcp_f32_e64 v177, v177 mul:2
  s_waitcnt vmcnt(16)
  v_mov_b32 v224, 0
  v_mov_b32 v225, 0
  v_mov_b32 v226, 0
  v_mov_b32 v227, 0
  v_lshl_add_u32 v23, v1, 4, s97
  s_cmp_eq_u32 s96, 0
  s_cbranch_scc0 L_cv_par1
  s_mov_b64 exec, 3
  ds_write_b128 v23, v[224:227] offset:0
  v_cmp_eq_u32 vcc, 1, v1
  v_lshlrev_b32 v222, 16, v222
  s_nop 0
  v_cndmask_b32 v227, 0, v222, vcc
  ds_write_b128 v23, v[224:227] offset:4160
  s_mov_b64 exec, -1
  s_branch L_cv_join
        L_cv_par1:
  s_mov_b64 exec, 0x3fffffff
  ds_write_b128 v23, v[224:227] offset:12416
  s_mov_b64 exec, -1
        L_cv_join:
  v_rcp_f32_e64 v178, v178 mul:2
  v_rcp_f32_e64 v179, v179 mul:2
  v_rcp_f32_e64 v180, v180 mul:2
  v_rcp_f32_e64 v181, v181 mul:2
  v_rcp_f32_e64 v182, v182 mul:2
  v_rcp_f32_e64 v183, v183 mul:2
  v_pk_fma_f32 v[168:169], v[80:81], v[168:169], v[80:81] neg_lo:[1,0,0] neg_hi:[1,0,0]
  v_pk_fma_f32 v[170:171], v[82:83], v[170:171], v[82:83] neg_lo:[1,0,0] neg_hi:[1,0,0]
  v_pk_fma_f32 v[172:173], v[84:85], v[172:173], v[84:85] neg_lo:[1,0,0] neg_hi:[1,0,0]
  v_pk_fma_f32 v[174:175], v[86:87], v[174:175], v[86:87] neg_lo:[1,0,0] neg_hi:[1,0,0]
  v_pk_fma_f32 v[176:177], v[88:89], v[176:177], v[88:89] neg_lo:[1,0,0] neg_hi:[1,0,0]
  v_pk_fma_f32 v[178:179], v[90:91], v[178:179], v[90:91] neg_lo:[1,0,0] neg_hi:[1,0,0]
  v_pk_fma_f32 v[180:181], v[92:93], v[180:181], v[92:93] neg_lo:[1,0,0] neg_hi:[1,0,0]
  v_pk_fma_f32 v[182:183], v[94:95], v[182:183], v[94:95] neg_lo:[1,0,0] neg_hi:[1,0,0]
  v_cvt_pk_bf16_f32 v184, v168, v169
  v_cvt_pk_bf16_f32 v185, v170, v171
  v_cvt_pk_bf16_f32 v186, v172, v173
  v_cvt_pk_bf16_f32 v187, v174, v175
  v_cvt_pk_bf16_f32 v188, v176, v177
  v_cvt_pk_bf16_f32 v189, v178, v179
  v_cvt_pk_bf16_f32 v190, v180, v181
  v_cvt_pk_bf16_f32 v191, v182, v183
  buffer_store_dwordx4 v[184:187], v18, s[28:31], s77 offen sc1
  v_pk_mul_f32 v[96:97], v[96:97], v[48:49]
  v_pk_mul_f32 v[98:99], v[98:99], v[48:49]
  v_pk_mul_f32 v[100:101], v[100:101], v[48:49]
  v_pk_mul_f32 v[102:103], v[102:103], v[48:49]
  v_pk_mul_f32 v[104:105], v[104:105], v[48:49]
  v_pk_mul_f32 v[106:107], v[106:107], v[48:49]
  v_pk_mul_f32 v[108:109], v[108:109], v[48:49]
  v_pk_mul_f32 v[110:111], v[110:111], v[48:49]
  buffer_store_dwordx4 v[188:191], v18, s[28:31], s77 offen offset:1024 sc1
  v_exp_f32 v168, v96
  v_exp_f32 v169, v97
  v_exp_f32 v170, v98
  v_exp_f32 v171, v99
  s_lshr_b32 s52, s2, 5
  s_lshl_b32 s52, s52, 9
  s_add_u32 s52, s52, 12587008
  v_lshlrev_b32 v52, 3, v1
  v_add_u32 v52, s52, v52
  buffer_load_dwordx2 v[50:51], v52, s[28:31], 0 offen sc1
  v_exp_f32 v172, v100
  v_exp_f32 v173, v101
  v_exp_f32 v174, v102
  v_exp_f32 v175, v103
  v_exp_f32 v176, v104
  v_exp_f32 v177, v105
  v_exp_f32 v178, v106
  v_exp_f32 v179, v107
  v_exp_f32 v180, v108
  v_exp_f32 v181, v109
  v_exp_f32 v182, v110
  v_exp_f32 v183, v111
  v_pk_add_f32 v[168:169], v[168:169], v[58:59]
  v_pk_add_f32 v[170:171], v[170:171], v[58:59]
  v_pk_add_f32 v[172:173], v[172:173], v[58:59]
  v_pk_add_f32 v[174:175], v[174:175], v[58:59]
  v_pk_add_f32 v[176:177], v[176:177], v[58:59]
  v_pk_add_f32 v[178:179], v[178:179], v[58:59]
  v_pk_add_f32 v[180:181], v[180:181], v[58:59]
  v_pk_add_f32 v[182:183], v[182:183], v[58:59]
  v_pk_fma_f32 v[168:169], v[168:169], v[168:169], v[58:59]
  v_pk_fma_f32 v[170:171], v[170:171], v[170:171], v[58:59]
  s_lshl_b32 s54, s4, 11
  s_add_u32 m0, s54, 143360
  s_nop 0
  buffer_load_dwordx4 v36, s[12:15], 0 offen lds
  v_pk_fma_f32 v[172:173], v[172:173], v[172:173], v[58:59]
  v_pk_fma_f32 v[174:175], v[174:175], v[174:175], v[58:59]
  v_pk_fma_f32 v[176:177], v[176:177], v[176:177], v[58:59]
  v_pk_fma_f32 v[178:179], v[178:179], v[178:179], v[58:59]
  v_pk_fma_f32 v[180:181], v[180:181], v[180:181], v[58:59]
  v_pk_fma_f32 v[182:183], v[182:183], v[182:183], v[58:59]
  v_rcp_f32_e64 v168, v168 mul:2
  v_rcp_f32_e64 v169, v169 mul:2
  v_rcp_f32_e64 v170, v170 mul:2
  v_rcp_f32_e64 v171, v171 mul:2
  v_rcp_f32_e64 v172, v172 mul:2
  v_rcp_f32_e64 v173, v173 mul:2
  v_rcp_f32_e64 v174, v174 mul:2
  v_rcp_f32_e64 v175, v175 mul:2
  v_rcp_f32_e64 v176, v176 mul:2
  v_rcp_f32_e64 v177, v177 mul:2
  v_rcp_f32_e64 v178, v178 mul:2
  v_rcp_f32_e64 v179, v179 mul:2
  v_rcp_f32_e64 v180, v180 mul:2
  v_rcp_f32_e64 v181, v181 mul:2
  v_rcp_f32_e64 v182, v182 mul:2
  s_lshl_b32 s54, s4, 11
  s_add_u32 m0, s54, 144384
  s_nop 0
  buffer_load_dwordx4 v37, s[12:15], 0 offen lds
  v_rcp_f32_e64 v183, v183 mul:2
  v_pk_fma_f32 v[168:169], v[96:97], v[168:169], v[96:97] neg_lo:[1,0,0] neg_hi:[1,0,0]
  v_pk_fma_f32 v[170:171], v[98:99], v[170:171], v[98:99] neg_lo:[1,0,0] neg_hi:[1,0,0]
  v_pk_fma_f32 v[172:173], v[100:101], v[172:173], v[100:101] neg_lo:[1,0,0] neg_hi:[1,0,0]
  v_pk_fma_f32 v[174:175], v[102:103], v[174:175], v[102:103] neg_lo:[1,0,0] neg_hi:[1,0,0]
  v_pk_fma_f32 v[176:177], v[104:105], v[176:177], v[104:105] neg_lo:[1,0,0] neg_hi:[1,0,0]
  v_pk_fma_f32 v[178:179], v[106:107], v[178:179], v[106:107] neg_lo:[1,0,0] neg_hi:[1,0,0]
  v_pk_fma_f32 v[180:181], v[108:109], v[180:181], v[108:109] neg_lo:[1,0,0] neg_hi:[1,0,0]
  v_pk_fma_f32 v[182:183], v[110:111], v[182:183], v[110:111] neg_lo:[1,0,0] neg_hi:[1,0,0]
  v_cvt_pk_bf16_f32 v184, v168, v169
  v_cvt_pk_bf16_f32 v185, v170, v171
  v_cvt_pk_bf16_f32 v186, v172, v173
  v_cvt_pk_bf16_f32 v187, v174, v175
  v_cvt_pk_bf16_f32 v188, v176, v177
  v_cvt_pk_bf16_f32 v189, v178, v179
  v_cvt_pk_bf16_f32 v190, v180, v181
  v_cvt_pk_bf16_f32 v191, v182, v183
  buffer_store_dwordx4 v[184:187], v18, s[28:31], s78 offen sc1
  v_pk_mul_f32 v[112:113], v[112:113], v[48:49]
  v_pk_mul_f32 v[114:115], v[114:115], v[48:49]
  v_pk_mul_f32 v[116:117], v[116:117], v[48:49]
  v_pk_mul_f32 v[118:119], v[118:119], v[48:49]
  v_pk_mul_f32 v[120:121], v[120:121], v[48:49]
  v_pk_mul_f32 v[122:123], v[122:123], v[48:49]
  v_pk_mul_f32 v[124:125], v[124:125], v[48:49]
  v_pk_mul_f32 v[126:127], v[126:127], v[48:49]
  buffer_store_dwordx4 v[188:191], v18, s[28:31], s78 offen offset:1024 sc1
  v_exp_f32 v168, v112
  v_exp_f32 v169, v113
  v_exp_f32 v170, v114
  v_exp_f32 v171, v115
  v_exp_f32 v172, v116
  v_exp_f32 v173, v117
  v_exp_f32 v174, v118
  v_exp_f32 v175, v119
  v_exp_f32 v176, v120
  v_exp_f32 v177, v121
  v_exp_f32 v178, v122
  v_exp_f32 v179, v123
  v_exp_f32 v180, v124
  s_waitcnt vmcnt(4)
  s_mov_b32 s62, 0
L_chk_fu:
  v_cmp_ne_u32 vcc, s50, v50
  v_cmp_ne_u32 s[84:85], s50, v51
  s_nop 3
  s_or_b64 vcc, vcc, s[84:85]
  s_cbranch_vccz L_ok_fu
  s_add_u32 s62, s62, 1
  s_cmp_gt_u32 s62, 65536
  s_cbranch_scc1 L_ok_fu
  s_sleep 4
  buffer_load_dwordx2 v[50:51], v52, s[28:31], 0 offen sc1
  s_waitcnt vmcnt(0)
  s_branch L_chk_fu
        L_ok_fu:
  s_add_u32 m0, s75, 8320
  s_nop 0
  buffer_load_dwordx4 v54, s[28:31], 0 offen sc1 lds
  v_exp_f32 v181, v125
  v_exp_f32 v182, v126
  v_exp_f32 v183, v127
  v_pk_add_f32 v[168:169], v[168:169], v[58:59]
  v_pk_add_f32 v[170:171], v[170:171], v[58:59]
  v_pk_add_f32 v[172:173], v[172:173], v[58:59]
  v_pk_add_f32 v[174:175], v[174:175], v[58:59]
  v_pk_add_f32 v[176:177], v[176:177], v[58:59]
  v_pk_add_f32 v[178:179], v[178:179], v[58:59]
  v_pk_add_f32 v[180:181], v[180:181], v[58:59]
  v_pk_add_f32 v[182:183], v[182:183], v[58:59]
  v_pk_fma_f32 v[168:169], v[168:169], v[168:169], v[58:59]
  v_pk_fma_f32 v[170:171], v[170:171], v[170:171], v[58:59]
  buffer_load_dwordx4 v54, s[28:31], 0 offen offset:1024 sc1 lds
  v_pk_fma_f32 v[172:173], v[172:173], v[172:173], v[58:59]
  v_pk_fma_f32 v[174:175], v[174:175], v[174:175], v[58:59]
  v_pk_fma_f32 v[176:177], v[176:177], v[176:177], v[58:59]
  v_pk_fma_f32 v[178:179], v[178:179], v[178:179], v[58:59]
  v_pk_fma_f32 v[180:181], v[180:181], v[180:181], v[58:59]
  v_pk_fma_f32 v[182:183], v[182:183], v[182:183], v[58:59]
  v_rcp_f32_e64 v168, v168 mul:2
  v_rcp_f32_e64 v169, v169 mul:2
  v_rcp_f32_e64 v170, v170 mul:2
  v_rcp_f32_e64 v171, v171 mul:2
  v_rcp_f32_e64 v172, v172 mul:2
  v_rcp_f32_e64 v173, v173 mul:2
  v_rcp_f32_e64 v174, v174 mul:2
  v_rcp_f32_e64 v175, v175 mul:2
  v_rcp_f32_e64 v176, v176 mul:2
  v_rcp_f32_e64 v177, v177 mul:2
  v_rcp_f32_e64 v178, v178 mul:2
  v_rcp_f32_e64 v179, v179 mul:2
  v_rcp_f32_e64 v180, v180 mul:2
  v_rcp_f32_e64 v181, v181 mul:2
  v_rcp_f32_e64 v182, v182 mul:2
  v_rcp_f32_e64 v183, v183 mul:2
  v_pk_fma_f32 v[168:169], v[112:113], v[168:169], v[112:113] neg_lo:[1,0,0] neg_hi:[1,0,0]
  v_pk_fma_f32 v[170:171], v[114:115], v[170:171], v[114:115] neg_lo:[1,0,0] neg_hi:[1,0,0]
  v_pk_fma_f32 v[172:173], v[116:117], v[172:173], v[116:117] neg_lo:[1,0,0] neg_hi:[1,0,0]
  v_pk_fma_f32 v[174:175], v[118:119], v[174:175], v[118:119] neg_lo:[1,0,0] neg_hi:[1,0,0]
  v_pk_fma_f32 v[176:177], v[120:121], v[176:177], v[120:121] neg_lo:[1,0,0] neg_hi:[1,0,0]
  v_pk_fma_f32 v[178:179], v[122:123], v[178:179], v[122:123] neg_lo:[1,0,0] neg_hi:[1,0,0]
  v_pk_fma_f32 v[180:181], v[124:125], v[180:181], v[124:125] neg_lo:[1,0,0] neg_hi:[1,0,0]
  v_pk_fma_f32 v[182:183], v[126:127], v[182:183], v[126:127] neg_lo:[1,0,0] neg_hi:[1,0,0]
  v_cvt_pk_bf16_f32 v184, v168, v169
  v_cvt_pk_bf16_f32 v185, v170, v171
  v_cvt_pk_bf16_f32 v186, v172, v173
  v_cvt_pk_bf16_f32 v187, v174, v175
  v_cvt_pk_bf16_f32 v188, v176, v177
  v_cvt_pk_bf16_f32 v189, v178, v179
  v_cvt_pk_bf16_f32 v190, v180, v181
  v_cvt_pk_bf16_f32 v191, v182, v183
  buffer_store_dwordx4 v[184:187], v18, s[28:31], s79 offen sc1
  buffer_store_dwordx4 v[188:191], v18, s[28:31], s79 offen offset:1024 sc1
  v_and_b32 v14, 15, v1
  v_add_u32 v15, 1, v14
  v_lshrrev_b32 v15, 1, v15
  v_lshrrev_b32 v20, 4, v1
  v_lshl_add_u32 v15, v20, 2, v15
  v_lshlrev_b32 v15, 2, v15
  v_and_b32 v16, 1, v1
  v_cmp_eq_u32 vcc, 0, v16
  v_mov_b32 v17, 4160
  s_nop 0
  v_cndmask_b32 v16, 0, v17, vcc
  s_lshl_b32 s53, s96, 6
  s_add_u32 s52, s97, s53
  v_add3_u32 v16, v16, v15, s52
  v_add_u32 v17, 1024, v16
  v_add_u32 v18, 2048, v16
  v_add_u32 v19, 3072, v16
  v_lshlrev_b32 v20, 4, v20
  v_lshlrev_b32 v14, 5, v14
  v_sub_u32 v20, v20, v14
  s_add_u32 s52, s52, 8800
  v_add_u32 v20, s52, v20
  s_waitcnt vmcnt(2)
  s_waitcnt lgkmcnt(0)
  s_barrier
  ds_read2_b32 v[160:161], v16 offset0:0 offset1:1
  ds_read2_b32 v[162:163], v16 offset0:2 offset1:3
  ds_read_b128 v[156:159], v20 offset:0
  ds_read_b128 v[152:155], v20 offset:512
  ds_read_b128 v[148:151], v20 offset:1024
  ds_read_b128 v[144:147], v20 offset:1536
  ds_read_b128 v[140:143], v20 offset:2048
  ds_read_b128 v[136:139], v20 offset:2560
  ds_read_b128 v[132:135], v20 offset:3072
  ds_read_b128 v[128:131], v20 offset:3584
  ds_read2_b32 v[164:165], v16 offset0:128 offset1:129
  ds_read2_b32 v[166:167], v16 offset0:130 offset1:131
  ds_read2_b32 v[168:169], v17 offset0:0 offset1:1
  ds_read2_b32 v[170:171], v17 offset0:2 offset1:3
  s_waitcnt lgkmcnt(11)
  v_mfma_f32_16x16x32_bf16 a[252:255], v[160:163], v[156:159], 0
  ds_read2_b32 v[172:173], v17 offset0:128 offset1:129
  ds_read2_b32 v[174:175], v17 offset0:130 offset1:131
  s_waitcnt lgkmcnt(12)
  v_mfma_f32_16x16x32_bf16 a[248:251], v[160:163], v[152:155], 0
  ds_read2_b32 v[176:177], v18 offset0:0 offset1:1
  ds_read2_b32 v[178:179], v18 offset0:2 offset1:3
  s_waitcnt lgkmcnt(13)
  v_mfma_f32_16x16x32_bf16 a[244:247], v[160:163], v[148:151], 0
  ds_read2_b32 v[180:181], v18 offset0:128 offset1:129
  ds_read2_b32 v[182:183], v18 offset0:130 offset1:131
  s_waitcnt lgkmcnt(14)
  v_mfma_f32_16x16x32_bf16 a[240:243], v[160:163], v[144:147], 0
  ds_read2_b32 v[184:185], v19 offset0:0 offset1:1
  ds_read2_b32 v[186:187], v19 offset0:2 offset1:3
  s_waitcnt lgkmcnt(15)
  v_mfma_f32_16x16x32_bf16 a[236:239], v[160:163], v[140:143], 0
  ds_read2_b32 v[188:189], v19 offset0:128 offset1:129
  ds_read2_b32 v[190:191], v19 offset0:130 offset1:131
  s_waitcnt lgkmcnt(15)
  v_mfma_f32_16x16x32_bf16 a[232:235], v[160:163], v[136:139], 0
  ds_read2_b32 v[96:97], v16 offset0:32 offset1:33
  ds_read2_b32 v[98:99], v16 offset0:34 offset1:35
  ds_read_b64_tr_b16 a[16:17], v33 offset:4096
  ds_read_b64_tr_b16 a[18:19], v33 offset:5120
  ds_read_b64_tr_b16 a[20:21], v34 offset:4096
  ds_read_b64_tr_b16 a[22:23], v34 offset:5120
  v_mfma_f32_16x16x32_bf16 a[228:231], v[160:163], v[132:135], 0
  ds_read_b128 v[92:95], v20 offset:128
  s_waitcnt lgkmcnt(15)
  v_mfma_f32_16x16x32_bf16 a[224:227], v[160:163], v[128:131], 0
  ds_read_b128 v[88:91], v20 offset:640
  s_add_u32 m0, s58, 0
  s_add_u32 s57, s73, 43008
  buffer_load_dwordx4 v32, s[32:35], s57 offen lds
  v_mfma_f32_16x16x32_bf16 a[252:255], v[164:167], v[152:155], a[252:255]
  ds_read_b128 v[84:87], v20 offset:1152
  v_mfma_f32_16x16x32_bf16 a[248:251], v[164:167], v[148:151], a[248:251]
  ds_read_b128 v[80:83], v20 offset:1664
  v_mfma_f32_16x16x32_bf16 a[244:247], v[164:167], v[144:147], a[244:247]
  ds_read_b128 v[76:79], v20 offset:2176
  buffer_load_dwordx4 v60, s[32:35], s57 offen offset:1024 lds
  v_mfma_f32_16x16x32_bf16 a[240:243], v[164:167], v[140:143], a[240:243]
  ds_read_b128 v[72:75], v20 offset:2688
  v_mfma_f32_16x16x32_bf16 a[236:239], v[164:167], v[136:139], a[236:239]
  ds_read_b128 v[68:71], v20 offset:3200
  v_mfma_f32_16x16x32_bf16 a[232:235], v[164:167], v[132:135], a[232:235]
  ds_read_b128 v[64:67], v20 offset:3712
  ds_read_b64_tr_b16 a[24:25], v33 offset:6144
  ds_read_b64_tr_b16 a[26:27], v33 offset:7168
  ds_read_b64_tr_b16 a[28:29], v34 offset:6144
  ds_read_b64_tr_b16 a[30:31], v34 offset:7168
  v_mfma_f32_16x16x32_bf16 a[228:231], v[164:167], v[128:131], a[228:231]
  ds_read2_b32 v[100:101], v16 offset0:160 offset1:161
  ds_read2_b32 v[102:103], v16 offset0:162 offset1:163
  v_mfma_f32_16x16x32_bf16 a[252:255], v[168:171], v[148:151], a[252:255]
  ds_read2_b32 v[104:105], v17 offset0:32 offset1:33
  ds_read2_b32 v[106:107], v17 offset0:34 offset1:35
  s_add_u32 m0, s58, 2048
  s_mul_i32 s73, s69, 57344
  s_add_u32 s57, s73, 0
  buffer_load_dwordx4 v32, s[32:35], s57 offen lds
  v_mfma_f32_16x16x32_bf16 a[248:251], v[168:171], v[144:147], a[248:251]
  ds_read2_b32 v[108:109], v17 offset0:160 offset1:161
  ds_read2_b32 v[110:111], v17 offset0:162 offset1:163
  v_mfma_f32_16x16x32_bf16 a[244:247], v[168:171], v[140:143], a[244:247]
  ds_read2_b32 v[112:113], v18 offset0:32 offset1:33
  ds_read2_b32 v[114:115], v18 offset0:34 offset1:35
  v_mfma_f32_16x16x32_bf16 a[240:243], v[168:171], v[136:139], a[240:243]
  ds_read2_b32 v[116:117], v18 offset0:160 offset1:161
  ds_read2_b32 v[118:119], v18 offset0:162 offset1:163
  buffer_load_dwordx4 v60, s[32:35], s57 offen offset:1024 lds
  v_mfma_f32_16x16x32_bf16 a[236:239], v[168:171], v[132:135], a[236:239]
  ds_read2_b32 v[120:121], v19 offset0:32 offset1:33
  ds_read2_b32 v[122:123], v19 offset0:34 offset1:35
  s_waitcnt vmcnt(4)
  s_lshl_b32 s52, s7, 8
  s_lshl_b32 s53, s8, 4
  s_add_u32 s52, s52, s53
  s_lshl_b32 s53, s4, 2
  s_add_u32 s52, s52, s53
  s_add_u32 s52, s52, 12591104
  v_mov_b32 v30, s52
  v_mov_b32 v31, s50
  s_mov_b64 exec, 1
  buffer_store_dword v31, v30, s[28:31], 0 offen sc1
  s_mov_b64 exec, -1
  v_mfma_f32_16x16x32_bf16 a[232:235], v[168:171], v[128:131], a[232:235]
  ds_read2_b32 v[124:125], v19 offset0:160 offset1:161
  ds_read2_b32 v[126:127], v19 offset0:162 offset1:163
  v_mfma_f32_16x16x32_bf16 a[252:255], v[172:175], v[144:147], a[252:255]
  ds_read_b64_tr_b16 a[32:33], v33 offset:8192
  ds_read_b64_tr_b16 a[34:35], v33 offset:9216
  ds_read_b64_tr_b16 a[36:37], v34 offset:8192
  ds_read_b64_tr_b16 a[38:39], v34 offset:9216
  v_mfma_f32_16x16x32_bf16 a[248:251], v[172:175], v[140:143], a[248:251]
  v_mfma_f32_16x16x32_bf16 a[244:247], v[172:175], v[136:139], a[244:247]
  v_mfma_f32_16x16x32_bf16 a[240:243], v[172:175], v[132:135], a[240:243]
  s_waitcnt lgkmcnt(15)
  s_add_u32 m0, s58, 4096
  s_add_u32 s57, s73, 14336
  buffer_load_dwordx4 v32, s[32:35], s57 offen lds
  v_mfma_f32_16x16x32_bf16 a[236:239], v[172:175], v[128:131], a[236:239]
  v_mfma_f32_16x16x32_bf16 a[252:255], v[176:179], v[140:143], a[252:255]
  buffer_load_dwordx4 v60, s[32:35], s57 offen offset:1024 lds
  v_mfma_f32_16x16x32_bf16 a[248:251], v[176:179], v[136:139], a[248:251]
  v_mfma_f32_16x16x32_bf16 a[244:247], v[176:179], v[132:135], a[244:247]
  v_mfma_f32_16x16x32_bf16 a[240:243], v[176:179], v[128:131], a[240:243]
  ds_read_b64_tr_b16 a[40:41], v35 offset:0
  ds_read_b64_tr_b16 a[42:43], v35 offset:1024
  ds_read_b64_tr_b16 a[44:45], v43 offset:0
  ds_read_b64_tr_b16 a[46:47], v43 offset:1024
  v_mfma_f32_16x16x32_bf16 a[252:255], v[180:183], v[136:139], a[252:255]
  v_mfma_f32_16x16x32_bf16 a[248:251], v[180:183], v[132:135], a[248:251]
  v_mfma_f32_16x16x32_bf16 a[244:247], v[180:183], v[128:131], a[244:247]
  s_add_u32 m0, s58, 6144
  s_add_u32 s57, s73, 28672
  buffer_load_dwordx4 v32, s[32:35], s57 offen lds
  v_mfma_f32_16x16x32_bf16 a[252:255], v[184:187], v[132:135], a[252:255]
  v_mfma_f32_16x16x32_bf16 a[248:251], v[184:187], v[128:131], a[248:251]
  v_mfma_f32_16x16x32_bf16 a[252:255], v[188:191], v[128:131], a[252:255]
  buffer_load_dwordx4 v60, s[32:35], s57 offen offset:1024 lds
  v_mfma_f32_16x16x32_bf16 a[252:255], v[96:99], v[92:95], a[252:255]
  ds_read2_b32 v[160:161], v16 offset0:64 offset1:65
  ds_read2_b32 v[162:163], v16 offset0:66 offset1:67
  v_mfma_f32_16x16x32_bf16 a[248:251], v[96:99], v[88:91], a[248:251]
  ds_read_b128 v[156:159], v20 offset:256
  ds_read_b64_tr_b16 a[48:49], v35 offset:2048
  ds_read_b64_tr_b16 a[50:51], v35 offset:3072
  ds_read_b64_tr_b16 a[52:53], v43 offset:2048
  ds_read_b64_tr_b16 a[54:55], v43 offset:3072
  v_mfma_f32_16x16x32_bf16 a[244:247], v[96:99], v[84:87], a[244:247]
  ds_read_b128 v[152:155], v20 offset:768
  v_mfma_f32_16x16x32_bf16 a[240:243], v[96:99], v[80:83], a[240:243]
  ds_read_b128 v[148:151], v20 offset:1280
  v_mfma_f32_16x16x32_bf16 a[236:239], v[96:99], v[76:79], a[236:239]
  ds_read_b128 v[144:147], v20 offset:1792
  s_waitcnt lgkmcnt(14)
  s_add_u32 m0, s58, 8192
  s_add_u32 s57, s73, 43008
  buffer_load_dwordx4 v32, s[32:35], s57 offen lds
  v_mfma_f32_16x16x32_bf16 a[232:235], v[96:99], v[72:75], a[232:235]
  ds_read_b128 v[140:143], v20 offset:2304
  v_mfma_f32_16x16x32_bf16 a[228:231], v[96:99], v[68:71], a[228:231]
  ds_read_b128 v[136:139], v20 offset:2816
  v_mfma_f32_16x16x32_bf16 a[224:227], v[96:99], v[64:67], a[224:227]
  ds_read_b128 v[132:135], v20 offset:3328
  buffer_load_dwordx4 v60, s[32:35], s57 offen offset:1024 lds
  v_mfma_f32_16x16x32_bf16 a[252:255], v[100:103], v[88:91], a[252:255]
  ds_read_b128 v[128:131], v20 offset:3840
  v_mfma_f32_16x16x32_bf16 a[248:251], v[100:103], v[84:87], a[248:251]
  ds_read2_b32 v[164:165], v16 offset0:192 offset1:193
  ds_read2_b32 v[166:167], v16 offset0:194 offset1:195
  v_mfma_f32_16x16x32_bf16 a[244:247], v[100:103], v[80:83], a[244:247]
  ds_read2_b32 v[168:169], v17 offset0:64 offset1:65
  ds_read2_b32 v[170:171], v17 offset0:66 offset1:67
  ds_read_b64_tr_b16 a[56:57], v35 offset:4096
  ds_read_b64_tr_b16 a[58:59], v35 offset:5120
  ds_read_b64_tr_b16 a[60:61], v43 offset:4096
  ds_read_b64_tr_b16 a[62:63], v43 offset:5120
  v_mfma_f32_16x16x32_bf16 a[240:243], v[100:103], v[76:79], a[240:243]
  ds_read2_b32 v[172:173], v17 offset0:192 offset1:193
  ds_read2_b32 v[174:175], v17 offset0:194 offset1:195
  v_mfma_f32_16x16x32_bf16 a[236:239], v[100:103], v[72:75], a[236:239]
  ds_read2_b32 v[176:177], v18 offset0:64 offset1:65
  ds_read2_b32 v[178:179], v18 offset0:66 offset1:67
  s_waitcnt lgkmcnt(15)
  s_add_u32 m0, s63, 0
  s_mul_i32 s73, s70, 57344
  s_add_u32 s57, s73, 0
  buffer_load_dwordx4 v32, s[32:35], s57 offen lds
  v_mfma_f32_16x16x32_bf16 a[232:235], v[100:103], v[68:71], a[232:235]
  ds_read2_b32 v[180:181], v18 offset0:192 offset1:193
  ds_read2_b32 v[182:183], v18 offset0:194 offset1:195
  v_mfma_f32_16x16x32_bf16 a[228:231], v[100:103], v[64:67], a[228:231]
  ds_read2_b32 v[184:185], v19 offset0:64 offset1:65
  ds_read2_b32 v[186:187], v19 offset0:66 offset1:67
  v_mfma_f32_16x16x32_bf16 a[252:255], v[104:107], v[84:87], a[252:255]
  ds_read2_b32 v[188:189], v19 offset0:192 offset1:193
  ds_read2_b32 v[190:191], v19 offset0:194 offset1:195
  buffer_load_dwordx4 v60, s[32:35], s57 offen offset:1024 lds
  v_mfma_f32_16x16x32_bf16 a[248:251], v[104:107], v[80:83], a[248:251]
  v_mfma_f32_16x16x32_bf16 a[244:247], v[104:107], v[76:79], a[244:247]
  v_mfma_f32_16x16x32_bf16 a[240:243], v[104:107], v[72:75], a[240:243]
  ds_read_b64_tr_b16 a[64:65], v35 offset:6144
  ds_read_b64_tr_b16 a[66:67], v35 offset:7168
  ds_read_b64_tr_b16 a[68:69], v43 offset:6144
  ds_read_b64_tr_b16 a[70:71], v43 offset:7168
  v_mfma_f32_16x16x32_bf16 a[236:239], v[104:107], v[68:71], a[236:239]
  v_mfma_f32_16x16x32_bf16 a[232:235], v[104:107], v[64:67], a[232:235]
  s_add_u32 m0, s63, 2048
  s_add_u32 s57, s73, 14336
  buffer_load_dwordx4 v32, s[32:35], s57 offen lds
  v_mfma_f32_16x16x32_bf16 a[252:255], v[108:111], v[80:83], a[252:255]
  v_mfma_f32_16x16x32_bf16 a[248:251], v[108:111], v[76:79], a[248:251]
  v_mfma_f32_16x16x32_bf16 a[244:247], v[108:111], v[72:75], a[244:247]
  buffer_load_dwordx4 v60, s[32:35], s57 offen offset:1024 lds
  v_mfma_f32_16x16x32_bf16 a[240:243], v[108:111], v[68:71], a[240:243]
  v_mfma_f32_16x16x32_bf16 a[236:239], v[108:111], v[64:67], a[236:239]
  v_mfma_f32_16x16x32_bf16 a[252:255], v[112:115], v[76:79], a[252:255]
  ds_read_b64_tr_b16 a[72:73], v35 offset:8192
  ds_read_b64_tr_b16 a[74:75], v35 offset:9216
  ds_read_b64_tr_b16 a[76:77], v43 offset:8192
  ds_read_b64_tr_b16 a[78:79], v43 offset:9216
  v_mfma_f32_16x16x32_bf16 a[248:251], v[112:115], v[72:75], a[248:251]
  v_mfma_f32_16x16x32_bf16 a[244:247], v[112:115], v[68:71], a[244:247]
  v_mfma_f32_16x16x32_bf16 a[240:243], v[112:115], v[64:67], a[240:243]
  s_waitcnt lgkmcnt(15)
  s_add_u32 m0, s63, 4096
  s_add_u32 s57, s73, 28672
  buffer_load_dwordx4 v32, s[32:35], s57 offen lds
  v_mfma_f32_16x16x32_bf16 a[252:255], v[116:119], v[72:75], a[252:255]
  v_mfma_f32_16x16x32_bf16 a[248:251], v[116:119], v[68:71], a[248:251]
  buffer_load_dwordx4 v60, s[32:35], s57 offen offset:1024 lds
  v_mfma_f32_16x16x32_bf16 a[244:247], v[116:119], v[64:67], a[244:247]
  v_mfma_f32_16x16x32_bf16 a[252:255], v[120:123], v[68:71], a[252:255]
  v_mfma_f32_16x16x32_bf16 a[248:251], v[120:123], v[64:67], a[248:251]
  ds_read_b64_tr_b16 a[80:81], v35 offset:10240
  ds_read_b64_tr_b16 a[82:83], v35 offset:11264
  ds_read_b64_tr_b16 a[84:85], v43 offset:10240
  ds_read_b64_tr_b16 a[86:87], v43 offset:11264
  v_mfma_f32_16x16x32_bf16 a[252:255], v[124:127], v[64:67], a[252:255]
  v_mfma_f32_16x16x32_bf16 a[252:255], v[160:163], v[156:159], a[252:255]
  ds_read2_b32 v[96:97], v16 offset0:96 offset1:97
  ds_read2_b32 v[98:99], v16 offset0:98 offset1:99
  v_mfma_f32_16x16x32_bf16 a[248:251], v[160:163], v[152:155], a[248:251]
  ds_read_b128 v[92:95], v20 offset:384
  s_waitcnt lgkmcnt(11)
  s_add_u32 m0, s63, 6144
  s_add_u32 s57, s73, 43008
  buffer_load_dwordx4 v32, s[32:35], s57 offen lds
  v_mfma_f32_16x16x32_bf16 a[244:247], v[160:163], v[148:151], a[244:247]
  ds_read_b128 v[88:91], v20 offset:896
  v_mfma_f32_16x16x32_bf16 a[240:243], v[160:163], v[144:147], a[240:243]
  ds_read_b128 v[84:87], v20 offset:1408
  v_mfma_f32_16x16x32_bf16 a[236:239], v[160:163], v[140:143], a[236:239]
  ds_read_b128 v[80:83], v20 offset:1920
  buffer_load_dwordx4 v60, s[32:35], s57 offen offset:1024 lds
  v_mfma_f32_16x16x32_bf16 a[232:235], v[160:163], v[136:139], a[232:235]
  ds_read_b128 v[76:79], v20 offset:2432
  v_mfma_f32_16x16x32_bf16 a[228:231], v[160:163], v[132:135], a[228:231]
  ds_read_b128 v[72:75], v20 offset:2944
  s_waitcnt vmcnt(17)
  ds_read_b64_tr_b16 a[88:89], v33 offset:0
  ds_read_b64_tr_b16 a[90:91], v33 offset:1024
  ds_read_b64_tr_b16 a[92:93], v34 offset:0
  ds_read_b64_tr_b16 a[94:95], v34 offset:1024
  v_mfma_f32_16x16x32_bf16 a[224:227], v[160:163], v[128:131], a[224:227]
  ds_read_b128 v[68:71], v20 offset:3456
  v_mfma_f32_16x16x32_bf16 a[252:255], v[164:167], v[152:155], a[252:255]
  ds_read_b128 v[64:67], v20 offset:3968
  v_mfma_f32_16x16x32_bf16 a[248:251], v[164:167], v[148:151], a[248:251]
  ds_read2_b32 v[100:101], v16 offset0:224 offset1:225
  ds_read2_b32 v[102:103], v16 offset0:226 offset1:227
  s_waitcnt lgkmcnt(15)
  s_add_u32 m0, s63, 8192
  s_mul_i32 s73, s71, 57344
  s_add_u32 s57, s73, 0
  buffer_load_dwordx4 v32, s[32:35], s57 offen lds
  v_mfma_f32_16x16x32_bf16 a[244:247], v[164:167], v[144:147], a[244:247]
  ds_read2_b32 v[104:105], v17 offset0:96 offset1:97
  ds_read2_b32 v[106:107], v17 offset0:98 offset1:99
  v_mfma_f32_16x16x32_bf16 a[240:243], v[164:167], v[140:143], a[240:243]
  ds_read2_b32 v[108:109], v17 offset0:224 offset1:225
  ds_read2_b32 v[110:111], v17 offset0:226 offset1:227
  v_mfma_f32_16x16x32_bf16 a[236:239], v[164:167], v[136:139], a[236:239]
  ds_read2_b32 v[112:113], v18 offset0:96 offset1:97
  ds_read2_b32 v[114:115], v18 offset0:98 offset1:99
  buffer_load_dwordx4 v60, s[32:35], s57 offen offset:1024 lds
  v_mfma_f32_16x16x32_bf16 a[232:235], v[164:167], v[132:135], a[232:235]
  ds_read2_b32 v[116:117], v18 offset0:224 offset1:225
  ds_read2_b32 v[118:119], v18 offset0:226 offset1:227
  v_mfma_f32_16x16x32_bf16 a[228:231], v[164:167], v[128:131], a[228:231]
  ds_read2_b32 v[120:121], v19 offset0:96 offset1:97
  ds_read2_b32 v[122:123], v19 offset0:98 offset1:99
  v_mfma_f32_16x16x32_bf16 a[252:255], v[168:171], v[148:151], a[252:255]
  ds_read2_b32 v[124:125], v19 offset0:224 offset1:225
  ds_read2_b32 v[126:127], v19 offset0:226 offset1:227
  s_waitcnt vmcnt(17)
  ds_read_b64_tr_b16 a[96:97], v33 offset:2048
  ds_read_b64_tr_b16 a[98:99], v33 offset:3072
  ds_read_b64_tr_b16 a[100:101], v34 offset:2048
  ds_read_b64_tr_b16 a[102:103], v34 offset:3072
  v_mfma_f32_16x16x32_bf16 a[248:251], v[168:171], v[144:147], a[248:251]
  v_mfma_f32_16x16x32_bf16 a[244:247], v[168:171], v[140:143], a[244:247]
  s_add_u32 m0, s63, 10240
  s_add_u32 s57, s73, 14336
  buffer_load_dwordx4 v32, s[32:35], s57 offen lds
  v_mfma_f32_16x16x32_bf16 a[240:243], v[168:171], v[136:139], a[240:243]
  v_mfma_f32_16x16x32_bf16 a[236:239], v[168:171], v[132:135], a[236:239]
  v_mfma_f32_16x16x32_bf16 a[232:235], v[168:171], v[128:131], a[232:235]
  buffer_load_dwordx4 v60, s[32:35], s57 offen offset:1024 lds
  v_mfma_f32_16x16x32_bf16 a[252:255], v[172:175], v[144:147], a[252:255]
  v_mfma_f32_16x16x32_bf16 a[248:251], v[172:175], v[140:143], a[248:251]
  v_mfma_f32_16x16x32_bf16 a[244:247], v[172:175], v[136:139], a[244:247]
  s_waitcnt vmcnt(16)
  ds_read_b64_tr_b16 a[104:105], v33 offset:4096
  ds_read_b64_tr_b16 a[106:107], v33 offset:5120
  ds_read_b64_tr_b16 a[108:109], v34 offset:4096
  ds_read_b64_tr_b16 a[110:111], v34 offset:5120
  v_mfma_f32_16x16x32_bf16 a[240:243], v[172:175], v[132:135], a[240:243]
  v_mfma_f32_16x16x32_bf16 a[236:239], v[172:175], v[128:131], a[236:239]
  s_waitcnt lgkmcnt(15)
  s_add_u32 m0, s58, 0
  s_add_u32 s57, s73, 28672
  buffer_load_dwordx4 v32, s[32:35], s57 offen lds
  v_mfma_f32_16x16x32_bf16 a[252:255], v[176:179], v[140:143], a[252:255]
  v_mfma_f32_16x16x32_bf16 a[248:251], v[176:179], v[136:139], a[248:251]
  v_mfma_f32_16x16x32_bf16 a[244:247], v[176:179], v[132:135], a[244:247]
  buffer_load_dwordx4 v60, s[32:35], s57 offen offset:1024 lds
  v_mfma_f32_16x16x32_bf16 a[240:243], v[176:179], v[128:131], a[240:243]
  v_mfma_f32_16x16x32_bf16 a[252:255], v[180:183], v[136:139], a[252:255]
  v_mfma_f32_16x16x32_bf16 a[248:251], v[180:183], v[132:135], a[248:251]
  s_waitcnt vmcnt(16)
  ds_read_b64_tr_b16 a[112:113], v33 offset:6144
  ds_read_b64_tr_b16 a[114:115], v33 offset:7168
  ds_read_b64_tr_b16 a[116:117], v34 offset:6144
  ds_read_b64_tr_b16 a[118:119], v34 offset:7168
  s_lshl_b32 s52, s7, 8
  s_add_u32 s52, s52, 12591104
  v_min_u32 v52, 55, v1
  v_lshlrev_b32 v52, 2, v52
  v_add_u32 v52, s52, v52
  buffer_load_dword v50, v52, s[28:31], 0 offen sc1
  v_mfma_f32_16x16x32_bf16 a[244:247], v[180:183], v[128:131], a[244:247]
  v_mfma_f32_16x16x32_bf16 a[252:255], v[184:187], v[132:135], a[252:255]
  v_mfma_f32_16x16x32_bf16 a[248:251], v[184:187], v[128:131], a[248:251]
  s_waitcnt lgkmcnt(8)
  s_add_u32 m0, s58, 2048
  s_add_u32 s57, s73, 43008
  buffer_load_dwordx4 v32, s[32:35], s57 offen lds
  v_mfma_f32_16x16x32_bf16 a[252:255], v[188:191], v[128:131], a[252:255]
  v_mfma_f32_16x16x32_bf16 a[252:255], v[96:99], v[92:95], a[252:255]
  buffer_load_dwordx4 v60, s[32:35], s57 offen offset:1024 lds
  v_mfma_f32_16x16x32_bf16 a[248:251], v[96:99], v[88:91], a[248:251]
  v_mfma_f32_16x16x32_bf16 a[244:247], v[96:99], v[84:87], a[244:247]
  v_mfma_f32_16x16x32_bf16 a[240:243], v[96:99], v[80:83], a[240:243]
  s_waitcnt vmcnt(17)
  ds_read_b64_tr_b16 a[120:121], v33 offset:8192
  ds_read_b64_tr_b16 a[122:123], v33 offset:9216
  ds_read_b64_tr_b16 a[124:125], v34 offset:8192
  ds_read_b64_tr_b16 a[126:127], v34 offset:9216
  v_mfma_f32_16x16x32_bf16 a[236:239], v[96:99], v[76:79], a[236:239]
  v_mfma_f32_16x16x32_bf16 a[232:235], v[96:99], v[72:75], a[232:235]
  v_mfma_f32_16x16x32_bf16 a[228:231], v[96:99], v[68:71], a[228:231]
  s_waitcnt lgkmcnt(8)
  s_add_u32 m0, s58, 4096
  s_mul_i32 s73, s72, 57344
  s_add_u32 s57, s73, 0
  buffer_load_dwordx4 v32, s[32:35], s57 offen lds
  v_mfma_f32_16x16x32_bf16 a[224:227], v[96:99], v[64:67], a[224:227]
  v_mfma_f32_16x16x32_bf16 a[252:255], v[100:103], v[88:91], a[252:255]
  v_mfma_f32_16x16x32_bf16 a[248:251], v[100:103], v[84:87], a[248:251]
  buffer_load_dwordx4 v60, s[32:35], s57 offen offset:1024 lds
  v_mfma_f32_16x16x32_bf16 a[244:247], v[100:103], v[80:83], a[244:247]
  v_mfma_f32_16x16x32_bf16 a[240:243], v[100:103], v[76:79], a[240:243]
  s_waitcnt vmcnt(17)
  ds_read_b64_tr_b16 a[128:129], v35 offset:0
  ds_read_b64_tr_b16 a[130:131], v35 offset:1024
  ds_read_b64_tr_b16 a[132:133], v43 offset:0
  ds_read_b64_tr_b16 a[134:135], v43 offset:1024
  v_mfma_f32_16x16x32_bf16 a[236:239], v[100:103], v[72:75], a[236:239]
  v_mfma_f32_16x16x32_bf16 a[232:235], v[100:103], v[68:71], a[232:235]
  v_mfma_f32_16x16x32_bf16 a[228:231], v[100:103], v[64:67], a[228:231]
  s_waitcnt lgkmcnt(8)
  s_add_u32 m0, s58, 6144
  s_add_u32 s57, s73, 14336
  buffer_load_dwordx4 v32, s[32:35], s57 offen lds
  v_mfma_f32_16x16x32_bf16 a[252:255], v[104:107], v[84:87], a[252:255]
  v_mfma_f32_16x16x32_bf16 a[248:251], v[104:107], v[80:83], a[248:251]
  v_mfma_f32_16x16x32_bf16 a[244:247], v[104:107], v[76:79], a[244:247]
  buffer_load_dwordx4 v60, s[32:35], s57 offen offset:1024 lds
  v_mfma_f32_16x16x32_bf16 a[240:243], v[104:107], v[72:75], a[240:243]
  v_mfma_f32_16x16x32_bf16 a[236:239], v[104:107], v[68:71], a[236:239]
  v_mfma_f32_16x16x32_bf16 a[232:235], v[104:107], v[64:67], a[232:235]
  s_waitcnt lgkmcnt(4)
  s_add_u32 m0, s58, 8192
  s_add_u32 s57, s73, 28672
  buffer_load_dwordx4 v32, s[32:35], s57 offen lds
  v_mfma_f32_16x16x32_bf16 a[252:255], v[108:111], v[80:83], a[252:255]
  v_mfma_f32_16x16x32_bf16 a[248:251], v[108:111], v[76:79], a[248:251]
  buffer_load_dwordx4 v60, s[32:35], s57 offen offset:1024 lds
  v_mfma_f32_16x16x32_bf16 a[244:247], v[108:111], v[72:75], a[244:247]
  v_mfma_f32_16x16x32_bf16 a[240:243], v[108:111], v[68:71], a[240:243]
  v_mfma_f32_16x16x32_bf16 a[236:239], v[108:111], v[64:67], a[236:239]
  s_waitcnt lgkmcnt(0)
  s_add_u32 m0, s63, 0
  s_add_u32 s57, s73, 43008
  buffer_load_dwordx4 v32, s[32:35], s57 offen lds
  v_mfma_f32_16x16x32_bf16 a[252:255], v[112:115], v[76:79], a[252:255]
  v_mfma_f32_16x16x32_bf16 a[248:251], v[112:115], v[72:75], a[248:251]
  v_mfma_f32_16x16x32_bf16 a[244:247], v[112:115], v[68:71], a[244:247]
  buffer_load_dwordx4 v60, s[32:35], s57 offen offset:1024 lds
  v_mfma_f32_16x16x32_bf16 a[240:243], v[112:115], v[64:67], a[240:243]
  v_mfma_f32_16x16x32_bf16 a[252:255], v[116:119], v[72:75], a[252:255]
  v_mfma_f32_16x16x32_bf16 a[248:251], v[116:119], v[68:71], a[248:251]
  v_mfma_f32_16x16x32_bf16 a[244:247], v[116:119], v[64:67], a[244:247]
  v_mfma_f32_16x16x32_bf16 a[252:255], v[120:123], v[68:71], a[252:255]
  v_mfma_f32_16x16x32_bf16 a[248:251], v[120:123], v[64:67], a[248:251]
  v_mfma_f32_16x16x32_bf16 a[252:255], v[124:127], v[64:67], a[252:255]
  s_waitcnt vmcnt(10)
  s_mov_b32 s62, 0
L_chk_fa:
  v_cmp_ne_u32 vcc, s50, v50
  s_nop 4
  s_cbranch_vccz L_ok_fa
  s_add_u32 s62, s62, 1
  s_cmp_gt_u32 s62, 65536
  s_cbranch_scc1 L_ok_fa
  s_sleep 4
  buffer_load_dword v50, v52, s[28:31], 0 offen sc1
  s_waitcnt vmcnt(0)
  s_branch L_chk_fa
        L_ok_fa:
  s_lshl_b32 s74, s3, 12
  buffer_load_dwordx4 v[128:131], v47, s[28:31], s74 offen offset:0 sc1
  buffer_load_dwordx4 v[132:135], v47, s[28:31], s74 offen offset:1024 sc1
  buffer_load_dwordx4 v[136:139], v47, s[28:31], s74 offen offset:2048 sc1
  buffer_load_dwordx4 v[140:143], v47, s[28:31], s74 offen offset:3072 sc1
  s_lshl_b32 s74, s67, 12
  buffer_load_dwordx4 v[144:147], v47, s[28:31], s74 offen offset:0 sc1
  buffer_load_dwordx4 v[148:151], v47, s[28:31], s74 offen offset:1024 sc1
  buffer_load_dwordx4 v[152:155], v47, s[28:31], s74 offen offset:2048 sc1
  buffer_load_dwordx4 v[156:159], v47, s[28:31], s74 offen offset:3072 sc1
  s_lshl_b32 s52, s4, 12
  s_add_u32 s52, s52, 75264
  v_lshlrev_b32 v14, 4, v1
  v_add_u32 v15, s52, v14
  s_xor_b32 s53, s4, 1
  s_lshl_b32 s53, s53, 12
  s_add_u32 s53, s53, 75264
  v_add_u32 v16, s53, v14
  v_and_b32 v17, 15, v1
  v_lshlrev_b32 v17, 5, v17
  v_lshrrev_b32 v18, 4, v1
  v_lshl_add_u32 v17, v18, 3, v17
  s_lshl_b32 s52, s96, 11
  s_sub_u32 s52, s97, s52
  s_add_u32 s52, s52, 10872
  v_sub_u32 v18, s52, v17
  s_lshl_b32 s74, s68, 12
  buffer_load_dwordx4 v[160:163], v47, s[28:31], s74 offen offset:0 sc1
  ds_read_b64 v[96:97], v18 offset:1536
  ds_read_b64 v[98:99], v18 offset:1024
  ds_read_b64 v[100:101], v18 offset:512
  ds_read_b64 v[102:103], v18 offset:0
  s_cmp_eq_u32 s96, 0
  s_cbranch_scc0 L_cv_e1
  ds_write_b128 v15, a[240:243] offset:0
  ds_write_b128 v15, a[244:247] offset:1024
  ds_write_b128 v15, a[248:251] offset:2048
  ds_write_b128 v15, a[252:255] offset:3072
  v_accvgpr_read_b32 v64, a224
  v_accvgpr_read_b32 v65, a225
  v_accvgpr_read_b32 v66, a226
  v_accvgpr_read_b32 v67, a227
  v_accvgpr_read_b32 v68, a228
  v_accvgpr_read_b32 v69, a229
  v_accvgpr_read_b32 v70, a230
  v_accvgpr_read_b32 v71, a231
  v_accvgpr_read_b32 v72, a232
  v_accvgpr_read_b32 v73, a233
  v_accvgpr_read_b32 v74, a234
  v_accvgpr_read_b32 v75, a235
  v_accvgpr_read_b32 v76, a236
  v_accvgpr_read_b32 v77, a237
  v_accvgpr_read_b32 v78, a238
  v_accvgpr_read_b32 v79, a239
  s_branch L_cv_e2
L_cv_e1:
  ds_write_b128 v15, a[224:227] offset:0
  ds_write_b128 v15, a[228:231] offset:1024
  ds_write_b128 v15, a[232:235] offset:2048
  ds_write_b128 v15, a[236:239] offset:3072
  v_accvgpr_read_b32 v64, a240
  v_accvgpr_read_b32 v65, a241
  v_accvgpr_read_b32 v66, a242
  v_accvgpr_read_b32 v67, a243
  v_accvgpr_read_b32 v68, a244
  v_accvgpr_read_b32 v69, a245
  v_accvgpr_read_b32 v70, a246
  v_accvgpr_read_b32 v71, a247
  v_accvgpr_read_b32 v72, a248
  v_accvgpr_read_b32 v73, a249
  v_accvgpr_read_b32 v74, a250
  v_accvgpr_read_b32 v75, a251
  v_accvgpr_read_b32 v76, a252
  v_accvgpr_read_b32 v77, a253
  v_accvgpr_read_b32 v78, a254
  v_accvgpr_read_b32 v79, a255
L_cv_e2:
  buffer_load_dwordx4 v[164:167], v47, s[28:31], s74 offen offset:1024 sc1
  s_waitcnt lgkmcnt(0)
  s_barrier
  ds_read_b128 v[80:83], v16 offset:0
  ds_read_b128 v[84:87], v16 offset:1024
  ds_read_b128 v[88:91], v16 offset:2048
  ds_read_b128 v[92:95], v16 offset:3072
  buffer_load_dwordx4 v[168:171], v47, s[28:31], s74 offen offset:2048 sc1
  v_and_b32 v104, 0xffff0000, v97
  v_lshlrev_b32 v105, 16, v97
  v_and_b32 v106, 0xffff0000, v96
  v_lshlrev_b32 v107, 16, v96
  v_and_b32 v108, 0xffff0000, v99
  v_lshlrev_b32 v109, 16, v99
  v_and_b32 v110, 0xffff0000, v98
  v_lshlrev_b32 v111, 16, v98
  v_and_b32 v112, 0xffff0000, v101
  v_lshlrev_b32 v113, 16, v101
  v_and_b32 v114, 0xffff0000, v100
  v_lshlrev_b32 v115, 16, v100
  v_and_b32 v116, 0xffff0000, v103
  v_lshlrev_b32 v117, 16, v103
  v_and_b32 v118, 0xffff0000, v102
  v_lshlrev_b32 v119, 16, v102
  buffer_load_dwordx4 v[172:175], v47, s[28:31], s74 offen offset:3072 sc1
  v_lshlrev_b32 v54, 16, v55
  v_pk_fma_f32 v[64:65], v[104:105], v[54:55], v[64:65] op_sel_hi:[1,0,1]
  v_pk_fma_f32 v[66:67], v[106:107], v[54:55], v[66:67] op_sel_hi:[1,0,1]
  v_pk_fma_f32 v[68:69], v[108:109], v[54:55], v[68:69] op_sel_hi:[1,0,1]
  v_pk_fma_f32 v[70:71], v[110:111], v[54:55], v[70:71] op_sel_hi:[1,0,1]
  v_pk_fma_f32 v[72:73], v[112:113], v[54:55], v[72:73] op_sel_hi:[1,0,1]
  v_pk_fma_f32 v[74:75], v[114:115], v[54:55], v[74:75] op_sel_hi:[1,0,1]
  v_pk_fma_f32 v[76:77], v[116:117], v[54:55], v[76:77] op_sel_hi:[1,0,1]
  v_pk_fma_f32 v[78:79], v[118:119], v[54:55], v[78:79] op_sel_hi:[1,0,1]
  s_lshl_b32 s74, s69, 12
  buffer_load_dwordx4 v[176:179], v47, s[28:31], s74 offen offset:0 sc1
  s_waitcnt lgkmcnt(0)
  v_pk_add_f32 v[64:65], v[64:65], v[80:81]
  v_pk_add_f32 v[66:67], v[66:67], v[82:83]
  v_pk_add_f32 v[68:69], v[68:69], v[84:85]
  v_pk_add_f32 v[70:71], v[70:71], v[86:87]
  v_pk_add_f32 v[72:73], v[72:73], v[88:89]
  v_pk_add_f32 v[74:75], v[74:75], v[90:91]
  v_pk_add_f32 v[76:77], v[76:77], v[92:93]
  v_pk_add_f32 v[78:79], v[78:79], v[94:95]
  v_cvt_pk_bf16_f32 v96, v64, v65
  v_cvt_pk_bf16_f32 v97, v66, v67
  v_cvt_pk_bf16_f32 v98, v68, v69
  v_cvt_pk_bf16_f32 v99, v70, v71
  v_cvt_pk_bf16_f32 v100, v72, v73
  v_cvt_pk_bf16_f32 v101, v74, v75
  v_cvt_pk_bf16_f32 v102, v76, v77
  v_cvt_pk_bf16_f32 v103, v78, v79
  buffer_load_dwordx4 v[180:183], v47, s[28:31], s74 offen offset:1024 sc1
  s_lshl_b32 s52, s4, 11
  s_add_u32 s52, s52, 91648
  v_add_u32 v17, s52, v17
  v_add_u32 v14, s52, v14
  ds_write_b64 v17, v[96:97] offset:0
  ds_write_b64 v17, v[98:99] offset:512
  ds_write_b64 v17, v[100:101] offset:1024
  ds_write_b64 v17, v[102:103] offset:1536
  s_lshl_b32 s52, s95, 12
  s_lshl_b32 s53, s96, 11
  s_add_u32 s52, s52, s53
  s_add_u32 s52, s52, 10485760
  v_lshlrev_b32 v15, 4, v1
  v_add_u32 v15, s52, v15
  s_waitcnt lgkmcnt(0)
  ds_read_b128 v[64:67], v14
  ds_read_b128 v[68:71], v14 offset:1024
  s_waitcnt lgkmcnt(1)
  buffer_store_dwordx4 v[64:67], v15, s[28:31], 0 offen sc1
  s_waitcnt lgkmcnt(0)
  buffer_store_dwordx4 v[68:71], v15, s[28:31], 0 offen offset:1024 sc1
  s_waitcnt vmcnt(15)
  v_mfma_f32_32x32x16_bf16 v[96:111], a[0:3], v[128:131], 0
  v_mfma_f32_32x32x16_bf16 v[112:127], a[4:7], v[128:131], 0
  s_waitcnt vmcnt(14)
  v_mfma_f32_32x32x16_bf16 v[96:111], a[8:11], v[132:135], v[96:111]
  v_mfma_f32_32x32x16_bf16 v[112:127], a[12:15], v[132:135], v[112:127]
  s_waitcnt vmcnt(13)
  v_mfma_f32_32x32x16_bf16 v[96:111], a[16:19], v[136:139], v[96:111]
  buffer_load_dwordx4 v[184:187], v47, s[28:31], s74 offen offset:2048 sc1
  v_mfma_f32_32x32x16_bf16 v[112:127], a[20:23], v[136:139], v[112:127]
  s_waitcnt vmcnt(13)
  v_mfma_f32_32x32x16_bf16 v[96:111], a[24:27], v[140:143], v[96:111]
  buffer_load_dwordx4 v[188:191], v47, s[28:31], s74 offen offset:3072 sc1
  v_mfma_f32_32x32x16_bf16 v[112:127], a[28:31], v[140:143], v[112:127]
  s_waitcnt vmcnt(13)
  v_mfma_f32_32x32x16_bf16 v[96:111], a[32:35], v[144:147], v[96:111]
  s_lshl_b32 s74, s70, 12
  buffer_load_dwordx4 v[192:195], v47, s[28:31], s74 offen offset:0 sc1
  v_mfma_f32_32x32x16_bf16 v[112:127], a[36:39], v[144:147], v[112:127]
  s_waitcnt vmcnt(13)
  v_mfma_f32_32x32x16_bf16 v[96:111], a[40:43], v[148:151], v[96:111]
  buffer_load_dwordx4 v[196:199], v47, s[28:31], s74 offen offset:1024 sc1
  v_mfma_f32_32x32x16_bf16 v[112:127], a[44:47], v[148:151], v[112:127]
  s_waitcnt vmcnt(13)
  v_mfma_f32_32x32x16_bf16 v[96:111], a[48:51], v[152:155], v[96:111]
  buffer_load_dwordx4 v[200:203], v47, s[28:31], s74 offen offset:2048 sc1
  v_mfma_f32_32x32x16_bf16 v[112:127], a[52:55], v[152:155], v[112:127]
  s_waitcnt vmcnt(13)
  v_mfma_f32_32x32x16_bf16 v[96:111], a[56:59], v[156:159], v[96:111]
  buffer_load_dwordx4 v[204:207], v47, s[28:31], s74 offen offset:3072 sc1
  v_mfma_f32_32x32x16_bf16 v[112:127], a[60:63], v[156:159], v[112:127]
  s_waitcnt vmcnt(13)
  v_mfma_f32_32x32x16_bf16 v[96:111], a[64:67], v[160:163], v[96:111]
  s_lshl_b32 s74, s71, 12
  buffer_load_dwordx4 v[128:131], v47, s[28:31], s74 offen offset:0 sc1
  v_mfma_f32_32x32x16_bf16 v[112:127], a[68:71], v[160:163], v[112:127]
  s_waitcnt vmcnt(13)
  v_mfma_f32_32x32x16_bf16 v[96:111], a[72:75], v[164:167], v[96:111]
  buffer_load_dwordx4 v[132:135], v47, s[28:31], s74 offen offset:1024 sc1
  v_mfma_f32_32x32x16_bf16 v[112:127], a[76:79], v[164:167], v[112:127]
  s_waitcnt vmcnt(8)
  s_lshr_b32 s52, s2, 5
  s_lshl_b32 s52, s52, 9
  s_and_b32 s53, s2, 31
  s_lshl_b32 s53, s53, 4
  s_add_u32 s52, s52, s53
  s_lshl_b32 s53, s4, 2
  s_add_u32 s52, s52, s53
  s_add_u32 s52, s52, 12599296
  v_mov_b32 v30, s52
  v_mov_b32 v31, s50
  s_mov_b64 exec, 1
  buffer_store_dword v31, v30, s[28:31], 0 offen sc1
  s_mov_b64 exec, -1
  v_mfma_f32_32x32x16_bf16 v[96:111], a[80:83], v[168:171], v[96:111]
  buffer_load_dwordx4 v[136:139], v47, s[28:31], s74 offen offset:2048 sc1
  v_mfma_f32_32x32x16_bf16 v[112:127], a[84:87], v[168:171], v[112:127]
  v_mfma_f32_32x32x16_bf16 v[96:111], a[88:91], v[172:175], v[96:111]
  buffer_load_dwordx4 v[140:143], v47, s[28:31], s74 offen offset:3072 sc1
  v_mfma_f32_32x32x16_bf16 v[112:127], a[92:95], v[172:175], v[112:127]
  v_mfma_f32_32x32x16_bf16 v[96:111], a[96:99], v[176:179], v[96:111]
  s_lshl_b32 s74, s72, 12
  buffer_load_dwordx4 v[144:147], v47, s[28:31], s74 offen offset:0 sc1
  v_mfma_f32_32x32x16_bf16 v[112:127], a[100:103], v[176:179], v[112:127]
  ds_read_b64_tr_b16 a[136:137], v35 offset:2048
  ds_read_b64_tr_b16 a[138:139], v35 offset:3072
  ds_read_b64_tr_b16 a[140:141], v43 offset:2048
  ds_read_b64_tr_b16 a[142:143], v43 offset:3072
  v_mfma_f32_32x32x16_bf16 v[96:111], a[104:107], v[180:183], v[96:111]
  buffer_load_dwordx4 v[148:151], v47, s[28:31], s74 offen offset:1024 sc1
  v_mfma_f32_32x32x16_bf16 v[112:127], a[108:111], v[180:183], v[112:127]
  ds_read_b64_tr_b16 a[144:145], v35 offset:4096
  ds_read_b64_tr_b16 a[146:147], v35 offset:5120
  ds_read_b64_tr_b16 a[148:149], v43 offset:4096
  ds_read_b64_tr_b16 a[150:151], v43 offset:5120
  s_waitcnt vmcnt(12)
  v_mfma_f32_32x32x16_bf16 v[96:111], a[112:115], v[184:187], v[96:111]
  buffer_load_dwordx4 v[152:155], v47, s[28:31], s74 offen offset:2048 sc1
  v_mfma_f32_32x32x16_bf16 v[112:127], a[116:119], v[184:187], v[112:127]
  ds_read_b64_tr_b16 a[152:153], v35 offset:6144
  ds_read_b64_tr_b16 a[154:155], v35 offset:7168
  ds_read_b64_tr_b16 a[156:157], v43 offset:6144
  ds_read_b64_tr_b16 a[158:159], v43 offset:7168
  s_waitcnt vmcnt(12)
  v_mfma_f32_32x32x16_bf16 v[96:111], a[120:123], v[188:191], v[96:111]
  buffer_load_dwordx4 v[156:159], v47, s[28:31], s74 offen offset:3072 sc1
  v_and_b32 v16, 31, v1
  v_lshlrev_b32 v17, 6, v16
  v_lshrrev_b32 v18, 5, v1
  v_mfma_f32_32x32x16_bf16 v[112:127], a[124:127], v[188:191], v[112:127]
  v_lshl_add_u32 v17, v18, 3, v17
  s_lshl_b32 s52, s4, 11
  s_add_u32 s52, s52, 143360
  v_add_u32 v17, s52, v17
  v_bfe_u32 v19, v1, 1, 2
  ds_read_b64_tr_b16 a[160:161], v35 offset:8192
  ds_read_b64_tr_b16 a[162:163], v35 offset:9216
  ds_read_b64_tr_b16 a[164:165], v43 offset:8192
  ds_read_b64_tr_b16 a[166:167], v43 offset:9216
  s_waitcnt vmcnt(12)
  v_mfma_f32_32x32x16_bf16 v[96:111], a[128:131], v[192:195], v[96:111]
  s_lshl_b32 s74, s3, 12
  buffer_load_dwordx4 v[160:163], v46, s[28:31], s74 offen offset:0 sc1
  v_xor_b32 v20, 0, v19
  v_lshl_add_u32 v38, v20, 4, v17
  v_xor_b32 v20, 1, v19
  v_mfma_f32_32x32x16_bf16 v[112:127], a[132:135], v[192:195], v[112:127]
  v_lshl_add_u32 v39, v20, 4, v17
  v_xor_b32 v20, 2, v19
  v_lshl_add_u32 v40, v20, 4, v17
  ds_read_b64_tr_b16 a[168:169], v35 offset:10240
  ds_read_b64_tr_b16 a[170:171], v35 offset:11264
  ds_read_b64_tr_b16 a[172:173], v43 offset:10240
  ds_read_b64_tr_b16 a[174:175], v43 offset:11264
  s_waitcnt lgkmcnt(15)
  s_waitcnt vmcnt(12)
  v_mfma_f32_32x32x16_bf16 v[96:111], a[136:139], v[196:199], v[96:111]
  buffer_load_dwordx4 v[164:167], v46, s[28:31], s74 offen offset:1024 sc1
  v_xor_b32 v20, 3, v19
  v_lshl_add_u32 v41, v20, 4, v17
  ds_read_b64 v[244:245], v38
  v_mfma_f32_32x32x16_bf16 v[112:127], a[140:143], v[196:199], v[112:127]
  ds_read_b64 v[246:247], v39
  ds_read_b64 v[248:249], v40
  ds_read_b64 v[250:251], v41
  ds_read_b64_tr_b16 a[176:177], v33 offset:0
  ds_read_b64_tr_b16 a[178:179], v33 offset:1024
  ds_read_b64_tr_b16 a[180:181], v34 offset:0
  ds_read_b64_tr_b16 a[182:183], v34 offset:1024
  s_waitcnt lgkmcnt(15)
  s_waitcnt vmcnt(12)
  v_mfma_f32_32x32x16_bf16 v[96:111], a[144:147], v[200:203], v[96:111]
  buffer_load_dwordx4 v[168:171], v46, s[28:31], s74 offen offset:2048 sc1
  v_bfe_u32 v19, v1, 2, 2
  v_lshl_add_u32 v19, v18, 2, v19
  v_lshlrev_b32 v19, 6, v19
  v_mfma_f32_32x32x16_bf16 v[112:127], a[148:151], v[200:203], v[112:127]
  v_bfe_u32 v20, v1, 4, 1
  v_lshlrev_b32 v20, 5, v20
  v_and_b32 v21, 3, v1
  ds_read_b64_tr_b16 a[184:185], v33 offset:2048
  ds_read_b64_tr_b16 a[186:187], v33 offset:3072
  ds_read_b64_tr_b16 a[188:189], v34 offset:2048
  ds_read_b64_tr_b16 a[190:191], v34 offset:3072
  s_waitcnt vmcnt(12)
  v_mfma_f32_32x32x16_bf16 v[96:111], a[152:155], v[204:207], v[96:111]
  buffer_load_dwordx4 v[172:175], v46, s[28:31], s74 offen offset:3072 sc1
  v_lshl_add_u32 v20, v21, 3, v20
  s_lshl_b32 s52, s4, 11
  s_add_u32 s52, s52, 151552
  v_add3_u32 v42, v19, v20, s52
  s_waitcnt lgkmcnt(4)
  v_mfma_f32_32x32x16_bf16 v[112:127], a[156:159], v[204:207], v[112:127]
  v_lshlrev_b32 v212, 16, v244
  v_and_b32 v213, 0xffff0000, v244
  v_lshlrev_b32 v214, 16, v245
  ds_read_b64_tr_b16 a[192:193], v33 offset:4096
  ds_read_b64_tr_b16 a[194:195], v33 offset:5120
  ds_read_b64_tr_b16 a[196:197], v34 offset:4096
  ds_read_b64_tr_b16 a[198:199], v34 offset:5120
  s_waitcnt vmcnt(12)
  v_mfma_f32_32x32x16_bf16 v[96:111], a[160:163], v[128:131], v[96:111]
  s_lshl_b32 s74, s67, 12
  buffer_load_dwordx4 v[176:179], v46, s[28:31], s74 offen offset:0 sc1
  v_and_b32 v215, 0xffff0000, v245
  v_lshlrev_b32 v216, 16, v246
  v_and_b32 v217, 0xffff0000, v246
  v_mfma_f32_32x32x16_bf16 v[112:127], a[164:167], v[128:131], v[112:127]
  v_lshlrev_b32 v218, 16, v247
  v_and_b32 v219, 0xffff0000, v247
  v_lshlrev_b32 v220, 16, v248
  ds_read_b64_tr_b16 a[200:201], v33 offset:6144
  ds_read_b64_tr_b16 a[202:203], v33 offset:7168
  ds_read_b64_tr_b16 a[204:205], v34 offset:6144
  ds_read_b64_tr_b16 a[206:207], v34 offset:7168
  s_waitcnt vmcnt(12)
  v_mfma_f32_32x32x16_bf16 v[96:111], a[168:171], v[132:135], v[96:111]
  buffer_load_dwordx4 v[180:183], v46, s[28:31], s74 offen offset:1024 sc1
  v_and_b32 v221, 0xffff0000, v248
  v_lshlrev_b32 v222, 16, v249
  v_and_b32 v223, 0xffff0000, v249
  v_mfma_f32_32x32x16_bf16 v[112:127], a[172:175], v[132:135], v[112:127]
  v_lshlrev_b32 v224, 16, v250
  v_and_b32 v225, 0xffff0000, v250
  v_lshlrev_b32 v226, 16, v251
  ds_read_b64_tr_b16 a[208:209], v33 offset:8192
  ds_read_b64_tr_b16 a[210:211], v33 offset:9216
  ds_read_b64_tr_b16 a[212:213], v34 offset:8192
  ds_read_b64_tr_b16 a[214:215], v34 offset:9216
  s_waitcnt vmcnt(11)
  v_mfma_f32_32x32x16_bf16 v[96:111], a[176:179], v[136:139], v[96:111]
  buffer_load_dwordx4 v[184:187], v46, s[28:31], s74 offen offset:2048 sc1
  v_and_b32 v227, 0xffff0000, v251
  v_and_b32 v45, 0xffff0000, v44
  v_rcp_f32 v45, v45
  v_mfma_f32_32x32x16_bf16 v[112:127], a[180:183], v[136:139], v[112:127]
  v_lshlrev_b32 v44, 16, v44
  v_sub_f32 v228, v212, v44
  v_sub_f32 v229, v213, v44
  ds_read_b64_tr_b16 a[216:217], v35 offset:0
  ds_read_b64_tr_b16 a[218:219], v35 offset:1024
  ds_read_b64_tr_b16 a[220:221], v43 offset:0
  ds_read_b64_tr_b16 a[222:223], v43 offset:1024
  s_waitcnt lgkmcnt(15)
  s_waitcnt vmcnt(11)
  v_mfma_f32_32x32x16_bf16 v[96:111], a[184:187], v[140:143], v[96:111]
  buffer_load_dwordx4 v[188:191], v46, s[28:31], s74 offen offset:3072 sc1
  v_sub_f32 v230, v214, v44
  v_sub_f32 v231, v215, v44
  v_sub_f32 v232, v216, v44
  v_mfma_f32_32x32x16_bf16 v[112:127], a[188:191], v[140:143], v[112:127]
  v_sub_f32 v233, v217, v44
  v_sub_f32 v234, v218, v44
  v_sub_f32 v235, v219, v44
  s_waitcnt lgkmcnt(12)
  s_waitcnt vmcnt(11)
  v_mfma_f32_32x32x16_bf16 v[96:111], a[192:195], v[144:147], v[96:111]
  s_lshl_b32 s74, s68, 12
  buffer_load_dwordx4 v[192:195], v46, s[28:31], s74 offen offset:0 sc1
  v_sub_f32 v236, v220, v44
  v_sub_f32 v237, v221, v44
  v_sub_f32 v238, v222, v44
  v_mfma_f32_32x32x16_bf16 v[112:127], a[196:199], v[144:147], v[112:127]
  v_sub_f32 v239, v223, v44
  v_sub_f32 v240, v224, v44
  v_sub_f32 v241, v225, v44
  s_waitcnt lgkmcnt(8)
  s_waitcnt vmcnt(11)
  v_mfma_f32_32x32x16_bf16 v[96:111], a[200:203], v[148:151], v[96:111]
  buffer_load_dwordx4 v[196:199], v46, s[28:31], s74 offen offset:1024 sc1
  v_sub_f32 v242, v226, v44
  v_sub_f32 v243, v227, v44
  v_mul_f32 v228, v228, v45
  v_mfma_f32_32x32x16_bf16 v[112:127], a[204:207], v[148:151], v[112:127]
  v_mul_f32 v229, v229, v45
  v_mul_f32 v230, v230, v45
  v_mul_f32 v231, v231, v45
  s_waitcnt lgkmcnt(4)
  s_waitcnt vmcnt(11)
  v_mfma_f32_32x32x16_bf16 v[96:111], a[208:211], v[152:155], v[96:111]
  buffer_load_dwordx4 v[200:203], v46, s[28:31], s74 offen offset:2048 sc1
  v_mul_f32 v232, v232, v45
  v_mul_f32 v233, v233, v45
  v_mul_f32 v234, v234, v45
  v_mfma_f32_32x32x16_bf16 v[112:127], a[212:215], v[152:155], v[112:127]
  v_mul_f32 v235, v235, v45
  v_mul_f32 v236, v236, v45
  v_mul_f32 v237, v237, v45
  s_waitcnt lgkmcnt(0)
  s_waitcnt vmcnt(11)
  v_mfma_f32_32x32x16_bf16 v[96:111], a[216:219], v[156:159], v[96:111]
  buffer_load_dwordx4 v[204:207], v46, s[28:31], s74 offen offset:3072 sc1
  v_mul_f32 v238, v238, v45
  v_mul_f32 v239, v239, v45
  v_mul_f32 v240, v240, v45
  v_mfma_f32_32x32x16_bf16 v[112:127], a[220:223], v[156:159], v[112:127]
  v_mul_f32 v241, v241, v45
  v_mul_f32 v242, v242, v45
  v_mul_f32 v243, v243, v45
  s_waitcnt lgkmcnt(0)
  s_barrier
  v_lshlrev_b32 v26, 4, v1
  s_xor_b32 s52, s4, 2
  s_mul_i32 s52, s52, 12288
  s_add_u32 s52, s52, 4096
  v_add_u32 v27, s52, v26
  s_xor_b32 s52, s4, 3
  s_mul_i32 s52, s52, 12288
  s_add_u32 s52, s52, 8192
  v_add_u32 v28, s52, v26
  s_waitcnt vmcnt(11)
  v_mfma_f32_32x32x16_bf16 v[64:79], a[0:3], v[160:163], 0
  s_lshl_b32 s74, s69, 12
  buffer_load_dwordx4 v[128:131], v46, s[28:31], s74 offen offset:0 sc1
  v_mfma_f32_32x32x16_bf16 v[80:95], a[4:7], v[160:163], 0
  s_waitcnt vmcnt(11)
  v_mfma_f32_32x32x16_bf16 v[64:79], a[8:11], v[164:167], v[64:79]
  buffer_load_dwordx4 v[132:135], v46, s[28:31], s74 offen offset:1024 sc1
  v_mfma_f32_32x32x16_bf16 v[80:95], a[12:15], v[164:167], v[80:95]
  s_waitcnt vmcnt(11)
  v_mfma_f32_32x32x16_bf16 v[64:79], a[16:19], v[168:171], v[64:79]
  buffer_load_dwordx4 v[136:139], v46, s[28:31], s74 offen offset:2048 sc1
  v_mfma_f32_32x32x16_bf16 v[80:95], a[20:23], v[168:171], v[80:95]
  ds_write_b128 v27, v[96:99] offset:0
  s_or_b32 s52, s2, s4
  s_cmp_lg_u32 s52, 0
  s_cbranch_scc1 L_nobump1
  v_lshlrev_b32 v16, 4, v1
  v_add_u32 v16, 12587008, v16
  v_lshlrev_b32 v17, 3, v1
  v_add_u32 v17, 12590080, v17
  v_lshlrev_b32 v18, 3, v1
  v_add_u32 v18, 12590592, v18
  buffer_load_dwordx4 v[56:59], v16, s[28:31], 0 offen sc1
  buffer_load_dwordx4 v[60:63], v16, s[28:31], 0 offen offset:1024 sc1
  buffer_load_dwordx4 v[208:211], v16, s[28:31], 0 offen offset:2048 sc1
  buffer_load_dwordx2 v[254:255], v17, s[28:31], 0 offen sc1
  buffer_load_dwordx2 v[252:253], v18, s[28:31], 0 offen sc1
L_nobump1:
  s_waitcnt vmcnt(11)
  v_mfma_f32_32x32x16_bf16 v[64:79], a[24:27], v[172:175], v[64:79]
  buffer_load_dwordx4 v[140:143], v46, s[28:31], s74 offen offset:3072 sc1
  v_mfma_f32_32x32x16_bf16 v[80:95], a[28:31], v[172:175], v[80:95]
  ds_write_b128 v27, v[100:103] offset:1024
  s_waitcnt vmcnt(11)
  v_mfma_f32_32x32x16_bf16 v[64:79], a[32:35], v[176:179], v[64:79]
  s_lshl_b32 s74, s70, 12
  buffer_load_dwordx4 v[144:147], v46, s[28:31], s74 offen offset:0 sc1
  v_mfma_f32_32x32x16_bf16 v[80:95], a[36:39], v[176:179], v[80:95]
  ds_write_b128 v27, v[104:107] offset:2048
  s_waitcnt vmcnt(11)
  v_mfma_f32_32x32x16_bf16 v[64:79], a[40:43], v[180:183], v[64:79]
  buffer_load_dwordx4 v[148:151], v46, s[28:31], s74 offen offset:1024 sc1
  v_mfma_f32_32x32x16_bf16 v[80:95], a[44:47], v[180:183], v[80:95]
  ds_write_b128 v27, v[108:111] offset:3072
  s_waitcnt vmcnt(11)
  v_mfma_f32_32x32x16_bf16 v[64:79], a[48:51], v[184:187], v[64:79]
  buffer_load_dwordx4 v[152:155], v46, s[28:31], s74 offen offset:2048 sc1
  v_mfma_f32_32x32x16_bf16 v[80:95], a[52:55], v[184:187], v[80:95]
  ds_write_b128 v28, v[112:115] offset:0
  s_waitcnt vmcnt(11)
  v_mfma_f32_32x32x16_bf16 v[64:79], a[56:59], v[188:191], v[64:79]
  buffer_load_dwordx4 v[156:159], v46, s[28:31], s74 offen offset:3072 sc1
  v_mfma_f32_32x32x16_bf16 v[80:95], a[60:63], v[188:191], v[80:95]
  ds_write_b128 v28, v[116:119] offset:1024
  s_waitcnt vmcnt(11)
  v_mfma_f32_32x32x16_bf16 v[64:79], a[64:67], v[192:195], v[64:79]
  s_lshl_b32 s74, s71, 12
  buffer_load_dwordx4 v[160:163], v46, s[28:31], s74 offen offset:0 sc1
  v_mfma_f32_32x32x16_bf16 v[80:95], a[68:71], v[192:195], v[80:95]
  ds_write_b128 v28, v[120:123] offset:2048
  s_waitcnt vmcnt(11)
  v_mfma_f32_32x32x16_bf16 v[64:79], a[72:75], v[196:199], v[64:79]
  buffer_load_dwordx4 v[164:167], v46, s[28:31], s74 offen offset:1024 sc1
  v_mfma_f32_32x32x16_bf16 v[80:95], a[76:79], v[196:199], v[80:95]
  ds_write_b128 v28, v[124:127] offset:3072
  s_waitcnt vmcnt(11)
  v_mfma_f32_32x32x16_bf16 v[64:79], a[80:83], v[200:203], v[64:79]
  buffer_load_dwordx4 v[168:171], v46, s[28:31], s74 offen offset:2048 sc1
  v_mfma_f32_32x32x16_bf16 v[80:95], a[84:87], v[200:203], v[80:95]
  s_waitcnt vmcnt(11)
  v_mfma_f32_32x32x16_bf16 v[64:79], a[88:91], v[204:207], v[64:79]
  buffer_load_dwordx4 v[172:175], v46, s[28:31], s74 offen offset:3072 sc1
  v_mfma_f32_32x32x16_bf16 v[80:95], a[92:95], v[204:207], v[80:95]
  s_waitcnt vmcnt(11)
  v_mfma_f32_32x32x16_bf16 v[64:79], a[96:99], v[128:131], v[64:79]
  s_lshl_b32 s74, s72, 12
  buffer_load_dwordx4 v[176:179], v46, s[28:31], s74 offen offset:0 sc1
  v_mfma_f32_32x32x16_bf16 v[80:95], a[100:103], v[128:131], v[80:95]
  s_waitcnt vmcnt(11)
  v_mfma_f32_32x32x16_bf16 v[64:79], a[104:107], v[132:135], v[64:79]
  buffer_load_dwordx4 v[180:183], v46, s[28:31], s74 offen offset:1024 sc1
  v_mfma_f32_32x32x16_bf16 v[80:95], a[108:111], v[132:135], v[80:95]
  s_waitcnt vmcnt(11)
  v_mfma_f32_32x32x16_bf16 v[64:79], a[112:115], v[136:139], v[64:79]
  buffer_load_dwordx4 v[184:187], v46, s[28:31], s74 offen offset:2048 sc1
  v_mfma_f32_32x32x16_bf16 v[80:95], a[116:119], v[136:139], v[80:95]
  s_or_b32 s52, s2, s4
  s_cmp_lg_u32 s52, 0
  s_cbranch_scc1 L_nobump2
  s_mov_b32 s62, 0
  s_waitcnt vmcnt(12)
L_bump_chk:
  v_xor_b32 v19, s50, v56
  v_xor_b32 v57, s50, v57
  v_or_b32 v19, v19, v57
  v_xor_b32 v58, s50, v58
  v_or_b32 v19, v19, v58
  v_xor_b32 v59, s50, v59
  v_or_b32 v19, v19, v59
  v_xor_b32 v60, s50, v60
  v_or_b32 v19, v19, v60
  v_xor_b32 v61, s50, v61
  v_or_b32 v19, v19, v61
  v_xor_b32 v62, s50, v62
  v_or_b32 v19, v19, v62
  v_xor_b32 v63, s50, v63
  v_or_b32 v19, v19, v63
  v_xor_b32 v208, s50, v208
  v_or_b32 v19, v19, v208
  v_xor_b32 v209, s50, v209
  v_or_b32 v19, v19, v209
  v_xor_b32 v210, s50, v210
  v_or_b32 v19, v19, v210
  v_xor_b32 v211, s50, v211
  v_or_b32 v19, v19, v211
  v_xor_b32 v254, s50, v254
  v_or_b32 v19, v19, v254
  v_xor_b32 v255, s50, v255
  v_or_b32 v19, v19, v255
  v_xor_b32 v252, s50, v252
  v_or_b32 v19, v19, v252
  v_xor_b32 v253, s50, v253
  v_or_b32 v19, v19, v253
  v_cmp_ne_u32 vcc, 0, v19
  s_nop 4
  s_cbranch_vccz L_bump_go
  s_add_u32 s62, s62, 1
  s_cmp_gt_u32 s62, 65536
  s_cbranch_scc1 L_nobump2
  s_sleep 4
  buffer_load_dwordx4 v[56:59], v16, s[28:31], 0 offen sc1
  buffer_load_dwordx4 v[60:63], v16, s[28:31], 0 offen offset:1024 sc1
  buffer_load_dwordx4 v[208:211], v16, s[28:31], 0 offen offset:2048 sc1
  buffer_load_dwordx2 v[254:255], v17, s[28:31], 0 offen sc1
  buffer_load_dwordx2 v[252:253], v18, s[28:31], 0 offen sc1
  s_waitcnt vmcnt(0)
  s_branch L_bump_chk
        L_bump_go:
  v_mov_b32 v19, 12582912
  v_mov_b32 v20, s50
  s_mov_b64 exec, 1
  buffer_store_dword v20, v19, s[28:31], 0 offen sc1
  s_mov_b64 exec, -1
        L_nobump2:
  s_waitcnt vmcnt(11)
  v_mfma_f32_32x32x16_bf16 v[64:79], a[120:123], v[140:143], v[64:79]
  buffer_load_dwordx4 v[188:191], v46, s[28:31], s74 offen offset:3072 sc1
  v_mfma_f32_32x32x16_bf16 v[80:95], a[124:127], v[140:143], v[80:95]
  s_waitcnt vmcnt(11)
  v_mfma_f32_32x32x16_bf16 v[64:79], a[128:131], v[144:147], v[64:79]
  v_lshrrev_b32 v58, 2, v1
  s_and_b32 s52, s4, 1
  s_lshl_b32 s52, s52, 5
  s_lshl_b32 s53, s6, 6
  s_add_u32 s52, s52, s53
  v_add_u32 v58, s52, v58
  v_lshlrev_b32 v58, 12, v58
  v_and_b32 v59, 3, v1
  v_lshl_add_u32 v58, v59, 4, v58
  s_lshr_b32 s52, s4, 1
  s_lshl_b32 s52, s52, 6
  s_lshl_b32 s53, s5, 7
  s_add_u32 s52, s52, s53
  s_add_u32 s52, s52, 10485760
  v_add_u32 v56, s52, v58
  v_add_u32 v57, 64512, v56
  v_mfma_f32_32x32x16_bf16 v[80:95], a[132:135], v[144:147], v[80:95]
  s_lshl_b32 s52, s6, 9
  s_add_u32 s52, s52, 12599296
  v_lshlrev_b32 v52, 3, v1
  v_add_u32 v52, s52, v52
  buffer_load_dwordx2 v[50:51], v52, s[28:31], 0 offen sc1
  s_waitcnt vmcnt(11)
  v_mfma_f32_32x32x16_bf16 v[64:79], a[136:139], v[148:151], v[64:79]
  v_mfma_f32_32x32x16_bf16 v[80:95], a[140:143], v[148:151], v[80:95]
  s_waitcnt vmcnt(10)
  v_mfma_f32_32x32x16_bf16 v[64:79], a[144:147], v[152:155], v[64:79]
  v_mfma_f32_32x32x16_bf16 v[80:95], a[148:151], v[152:155], v[80:95]
  s_waitcnt vmcnt(9)
  v_mfma_f32_32x32x16_bf16 v[64:79], a[152:155], v[156:159], v[64:79]
  v_mfma_f32_32x32x16_bf16 v[80:95], a[156:159], v[156:159], v[80:95]
  s_waitcnt vmcnt(8)
  v_mfma_f32_32x32x16_bf16 v[64:79], a[160:163], v[160:163], v[64:79]
  v_mfma_f32_32x32x16_bf16 v[80:95], a[164:167], v[160:163], v[80:95]
  s_waitcnt vmcnt(7)
  v_mfma_f32_32x32x16_bf16 v[64:79], a[168:171], v[164:167], v[64:79]
  v_mfma_f32_32x32x16_bf16 v[80:95], a[172:175], v[164:167], v[80:95]
  s_waitcnt vmcnt(6)
  v_mfma_f32_32x32x16_bf16 v[80:95], a[180:183], v[168:171], v[80:95]
  s_waitcnt vmcnt(5)
  v_mfma_f32_32x32x16_bf16 v[80:95], a[188:191], v[172:175], v[80:95]
  s_waitcnt vmcnt(0)
  s_mov_b32 s62, 0
L_chk_fz:
  v_cmp_ne_u32 vcc, s50, v50
  v_cmp_ne_u32 s[84:85], s50, v51
  s_nop 3
  s_or_b64 vcc, vcc, s[84:85]
  s_cbranch_vccz L_ok_fz
  s_add_u32 s62, s62, 1
  s_cmp_gt_u32 s62, 65536
  s_cbranch_scc1 L_ok_fz
  s_sleep 4
  buffer_load_dwordx2 v[50:51], v52, s[28:31], 0 offen sc1
  s_waitcnt vmcnt(0)
  s_branch L_chk_fz
        L_ok_fz:
  s_lshl_b32 s54, s4, 11
  s_add_u32 m0, s54, 151552
  s_nop 0
  buffer_load_dwordx4 v56, s[28:31], 0 offen sc1 lds
  buffer_load_dwordx4 v57, s[28:31], 0 offen offset:1024 sc1 lds
  v_mfma_f32_32x32x16_bf16 v[80:95], a[196:199], v[176:179], v[80:95]
  v_mfma_f32_32x32x16_bf16 v[80:95], a[204:207], v[180:183], v[80:95]
  v_mfma_f32_32x32x16_bf16 v[80:95], a[212:215], v[184:187], v[80:95]
  v_mfma_f32_32x32x16_bf16 v[80:95], a[220:223], v[188:191], v[80:95]
  s_xor_b32 s52, s4, 1
  s_mul_i32 s52, s52, 12288
  s_add_u32 s52, s52, 0
  v_add_u32 v27, s52, v26
  s_mul_i32 s52, s4, 12288
  s_add_u32 s52, s52, 0
  v_add_u32 v15, s52, v26
  v_mfma_f32_32x32x16_bf16 v[64:79], a[176:179], v[168:171], v[64:79]
  v_mfma_f32_32x32x16_bf16 v[64:79], a[184:187], v[172:175], v[64:79]
  v_mfma_f32_32x32x16_bf16 v[64:79], a[192:195], v[176:179], v[64:79]
  s_nop 1
  ds_write_b128 v27, v[80:83] offset:0
  v_mfma_f32_32x32x16_bf16 v[64:79], a[200:203], v[180:183], v[64:79]
  ds_write_b128 v27, v[84:87] offset:1024
  v_mfma_f32_32x32x16_bf16 v[64:79], a[208:211], v[184:187], v[64:79]
  ds_write_b128 v27, v[88:91] offset:2048
  v_mfma_f32_32x32x16_bf16 v[64:79], a[216:219], v[188:191], v[64:79]
  ds_write_b128 v27, v[92:95] offset:3072
  s_mov_b32 s54, 0x3f317218
  s_waitcnt lgkmcnt(0)
  s_barrier
  ds_read_b128 v[144:147], v15 offset:4096
  ds_read_b128 v[148:151], v15 offset:5120
  ds_read_b128 v[152:155], v15 offset:6144
  ds_read_b128 v[156:159], v15 offset:7168
  ds_read_b128 v[160:163], v15 offset:8192
  ds_read_b128 v[164:167], v15 offset:9216
  ds_read_b128 v[168:171], v15 offset:10240
  ds_read_b128 v[172:175], v15 offset:11264
  ds_read_b128 v[128:131], v15 offset:0
  ds_read_b128 v[132:135], v15 offset:1024
  ds_read_b128 v[136:139], v15 offset:2048
  ds_read_b128 v[140:143], v15 offset:3072
  s_waitcnt lgkmcnt(8)
  v_pk_add_f32 v[64:65], v[64:65], v[144:145]
  v_pk_add_f32 v[66:67], v[66:67], v[146:147]
  v_pk_add_f32 v[68:69], v[68:69], v[148:149]
  v_pk_add_f32 v[70:71], v[70:71], v[150:151]
  v_pk_add_f32 v[72:73], v[72:73], v[152:153]
  v_pk_add_f32 v[74:75], v[74:75], v[154:155]
  v_pk_add_f32 v[76:77], v[76:77], v[156:157]
  v_pk_add_f32 v[78:79], v[78:79], v[158:159]
  s_waitcnt lgkmcnt(4)
  v_pk_add_f32 v[64:65], v[64:65], v[160:161]
  v_pk_add_f32 v[66:67], v[66:67], v[162:163]
  v_pk_add_f32 v[68:69], v[68:69], v[164:165]
  v_pk_add_f32 v[70:71], v[70:71], v[166:167]
  v_pk_add_f32 v[72:73], v[72:73], v[168:169]
  v_pk_add_f32 v[74:75], v[74:75], v[170:171]
  v_pk_add_f32 v[76:77], v[76:77], v[172:173]
  v_pk_add_f32 v[78:79], v[78:79], v[174:175]
  s_waitcnt lgkmcnt(0)
  v_pk_add_f32 v[64:65], v[64:65], v[128:129]
  v_pk_add_f32 v[66:67], v[66:67], v[130:131]
  v_pk_add_f32 v[68:69], v[68:69], v[132:133]
  v_pk_add_f32 v[70:71], v[70:71], v[134:135]
  v_pk_add_f32 v[72:73], v[72:73], v[136:137]
  v_pk_add_f32 v[74:75], v[74:75], v[138:139]
  v_pk_add_f32 v[76:77], v[76:77], v[140:141]
  v_pk_add_f32 v[78:79], v[78:79], v[142:143]
  s_waitcnt vmcnt(0)
  ds_read_b64_tr_b16 v[244:245], v42 offset:0
  ds_read_b64_tr_b16 v[246:247], v42 offset:512
  ds_read_b64_tr_b16 v[248:249], v42 offset:1024
  ds_read_b64_tr_b16 v[250:251], v42 offset:1536
  s_waitcnt lgkmcnt(0)
  v_lshlrev_b32 v252, 16, v244
  v_and_b32 v253, 0xffff0000, v244
  v_pk_fma_f32 v[212:213], v[228:229], v[252:253], v[212:213]
  v_lshlrev_b32 v252, 16, v245
  v_and_b32 v253, 0xffff0000, v245
  v_pk_fma_f32 v[214:215], v[230:231], v[252:253], v[214:215]
  v_lshlrev_b32 v252, 16, v246
  v_and_b32 v253, 0xffff0000, v246
  v_pk_fma_f32 v[216:217], v[232:233], v[252:253], v[216:217]
  v_lshlrev_b32 v252, 16, v247
  v_and_b32 v253, 0xffff0000, v247
  v_pk_fma_f32 v[218:219], v[234:235], v[252:253], v[218:219]
  v_lshlrev_b32 v252, 16, v248
  v_and_b32 v253, 0xffff0000, v248
  v_pk_fma_f32 v[220:221], v[236:237], v[252:253], v[220:221]
  v_lshlrev_b32 v252, 16, v249
  v_and_b32 v253, 0xffff0000, v249
  v_pk_fma_f32 v[222:223], v[238:239], v[252:253], v[222:223]
  v_lshlrev_b32 v252, 16, v250
  v_and_b32 v253, 0xffff0000, v250
  v_pk_fma_f32 v[224:225], v[240:241], v[252:253], v[224:225]
  v_lshlrev_b32 v252, 16, v251
  v_and_b32 v253, 0xffff0000, v251
  v_pk_fma_f32 v[226:227], v[242:243], v[252:253], v[226:227]
  v_mov_b32 v58, s54
  v_mov_b32 v59, s54
  v_pk_fma_f32 v[64:65], v[64:65], v[58:59], v[212:213]
  v_pk_fma_f32 v[66:67], v[66:67], v[58:59], v[214:215]
  v_pk_fma_f32 v[68:69], v[68:69], v[58:59], v[216:217]
  v_pk_fma_f32 v[70:71], v[70:71], v[58:59], v[218:219]
  v_pk_fma_f32 v[72:73], v[72:73], v[58:59], v[220:221]
  v_pk_fma_f32 v[74:75], v[74:75], v[58:59], v[222:223]
  v_pk_fma_f32 v[76:77], v[76:77], v[58:59], v[224:225]
  v_pk_fma_f32 v[78:79], v[78:79], v[58:59], v[226:227]
  v_cvt_pk_bf16_f32 v244, v64, v65
  v_cvt_pk_bf16_f32 v245, v66, v67
  v_cvt_pk_bf16_f32 v246, v68, v69
  v_cvt_pk_bf16_f32 v247, v70, v71
  v_cvt_pk_bf16_f32 v248, v72, v73
  v_cvt_pk_bf16_f32 v249, v74, v75
  v_cvt_pk_bf16_f32 v250, v76, v77
  v_cvt_pk_bf16_f32 v251, v78, v79
  ds_write_b64 v38, v[244:245]
  ds_write_b64 v39, v[246:247]
  ds_write_b64 v40, v[248:249]
  ds_write_b64 v41, v[250:251]
  s_lshl_b32 s52, s4, 11
  s_add_u32 s52, s52, 143360
  v_add_u32 v14, s52, v26
  s_waitcnt lgkmcnt(0)
  ds_read_b128 v[128:131], v14
  ds_read_b128 v[132:135], v14 offset:1024
  s_waitcnt lgkmcnt(1)
  buffer_store_dwordx4 v[128:131], v36, s[40:43], 0 offen sc1
  s_waitcnt lgkmcnt(0)
  buffer_store_dwordx4 v[132:135], v37, s[40:43], 0 offen sc1
L_end:
  s_endpgm
    L_helper:
  v_lshrrev_b32 v2, 6, v0
  v_and_b32 v1, 63, v0
  v_lshrrev_b32 v3, 3, v1
  v_and_b32 v4, 7, v1
  v_readfirstlane_b32 s4, v2
  s_lshl_b32 s5, s2, 6
  s_nop 2
  s_lshl_b32 s6, s4, 4
  s_add_u32 s5, s5, s6
  v_add_u32 v5, s5, v3
  v_mul_u32_u24 v6, 896, v5
  v_lshl_add_u32 v6, v4, 4, v6
  v_add_u32 v7, 7168, v6
  v_mov_b32 v8, 12582912
  v_mov_b32 v9, 0x3f803f80
  s_waitcnt lgkmcnt(0)
  s_mov_b32 s12, s64
  s_mov_b32 s13, s65
  s_mov_b32 s14, 1835008
  s_mov_b32 s15, 0x00020000
  s_mov_b32 s28, s88
  s_mov_b32 s29, s89
  s_mov_b32 s30, 13631488
  s_mov_b32 s31, 0x00020000
  buffer_load_dword v10, v8, s[28:31], 0 offen sc1
  s_mov_b32 s24, s78
  s_mov_b32 s25, s79
  s_mov_b32 s26, 1605632
  s_mov_b32 s27, 0x00020000
  s_cmp_ge_u32 s2, 28
  s_cbranch_scc1 L_hcs_a
  s_mul_i32 s6, s4, 112
  v_add_u32 v96, s6, v3
  v_mul_u32_u24 v96, 3584, v96
  v_lshl_add_u32 v96, v4, 4, v96
  s_lshl_b32 s6, s2, 7
  v_add_u32 v96, s6, v96
  s_mov_b32 s7, 0
  buffer_load_dwordx4 v[112:115], v96, s[24:27], s7 offen
  s_add_u32 s7, s7, 28672
  buffer_load_dwordx4 v[116:119], v96, s[24:27], s7 offen
  s_add_u32 s7, s7, 28672
  buffer_load_dwordx4 v[120:123], v96, s[24:27], s7 offen
  s_add_u32 s7, s7, 28672
  buffer_load_dwordx4 v[124:127], v96, s[24:27], s7 offen
  s_add_u32 s7, s7, 28672
  buffer_load_dwordx4 v[128:131], v96, s[24:27], s7 offen
  s_add_u32 s7, s7, 28672
  buffer_load_dwordx4 v[132:135], v96, s[24:27], s7 offen
  s_add_u32 s7, s7, 28672
  buffer_load_dwordx4 v[136:139], v96, s[24:27], s7 offen
  s_add_u32 s7, s7, 28672
  buffer_load_dwordx4 v[140:143], v96, s[24:27], s7 offen
  s_add_u32 s7, s7, 28672
  buffer_load_dwordx4 v[144:147], v96, s[24:27], s7 offen
  s_add_u32 s7, s7, 28672
  buffer_load_dwordx4 v[148:151], v96, s[24:27], s7 offen
  s_add_u32 s7, s7, 28672
  buffer_load_dwordx4 v[152:155], v96, s[24:27], s7 offen
  s_add_u32 s7, s7, 28672
  buffer_load_dwordx4 v[156:159], v96, s[24:27], s7 offen
  s_add_u32 s7, s7, 28672
  buffer_load_dwordx4 v[160:163], v96, s[24:27], s7 offen
  s_add_u32 s7, s7, 28672
  buffer_load_dwordx4 v[164:167], v96, s[24:27], s7 offen
  s_add_u32 s7, s7, 28672
L_hcs_a:
  buffer_load_dwordx4 v[16:19], v6, s[12:15], 0 offen offset:0
  buffer_load_dwordx4 v[20:23], v6, s[12:15], 0 offen offset:128
  buffer_load_dwordx4 v[24:27], v6, s[12:15], 0 offen offset:256
  buffer_load_dwordx4 v[28:31], v6, s[12:15], 0 offen offset:384
  buffer_load_dwordx4 v[32:35], v6, s[12:15], 0 offen offset:512
  buffer_load_dwordx4 v[36:39], v6, s[12:15], 0 offen offset:640
  buffer_load_dwordx4 v[40:43], v6, s[12:15], 0 offen offset:768
  buffer_load_dwordx4 v[44:47], v7, s[12:15], 0 offen offset:0
  buffer_load_dwordx4 v[48:51], v7, s[12:15], 0 offen offset:128
  buffer_load_dwordx4 v[52:55], v7, s[12:15], 0 offen offset:256
  buffer_load_dwordx4 v[56:59], v7, s[12:15], 0 offen offset:384
  buffer_load_dwordx4 v[60:63], v7, s[12:15], 0 offen offset:512
  buffer_load_dwordx4 v[64:67], v7, s[12:15], 0 offen offset:640
  buffer_load_dwordx4 v[68:71], v7, s[12:15], 0 offen offset:768
  v_mov_b32 v94, 0
  s_mov_b32 s16, s66
  s_mov_b32 s17, s67
  s_mov_b32 s18, 1835008
  s_mov_b32 s19, 0x00020000
  buffer_load_dword v95, v94, s[16:19], 0 offen
  s_mov_b32 s16, s68
  s_mov_b32 s17, s69
  s_mov_b32 s18, 1835008
  s_mov_b32 s19, 0x00020000
  buffer_load_dword v95, v94, s[16:19], 0 offen
  s_mov_b32 s16, s82
  s_mov_b32 s17, s83
  s_mov_b32 s18, 1605632
  s_mov_b32 s19, 0x00020000
  buffer_load_dword v95, v94, s[16:19], 0 offen
  s_mov_b32 s16, s72
  s_mov_b32 s17, s73
  s_mov_b32 s18, 1835008
  s_mov_b32 s19, 0x00020000
  buffer_load_dword v95, v94, s[16:19], 0 offen
  s_mov_b32 s10, 114688
  buffer_load_dword v95, v94, s[28:31], s10 offen
  s_mov_b32 s10, 2211840
  buffer_load_dword v95, v94, s[28:31], s10 offen
  s_mov_b32 s10, 4308992
  buffer_load_dword v95, v94, s[28:31], s10 offen
  s_mov_b32 s10, 6406144
  buffer_load_dword v95, v94, s[28:31], s10 offen
  s_mov_b32 s10, 10223616
  buffer_load_dword v95, v94, s[28:31], s10 offen
  s_mov_b32 s10, 12320768
  buffer_load_dword v95, v94, s[28:31], s10 offen
  s_waitcnt vmcnt(24)
  v_readfirstlane_b32 s50, v10
  s_nop 3
  s_mul_i32 s50, s50, 0x9e3779b1
  s_add_u32 s50, s50, 0x7f4a7c15
  s_cmp_ge_u32 s2, 28
  s_cbranch_scc1 L_hcs_b
  v_mov_b32 v168, 0
  v_mov_b32 v169, 0
  v_mov_b32 v170, 0
  v_mov_b32 v171, 0
  v_mov_b32 v172, 0
  v_mov_b32 v173, 0
  v_mov_b32 v174, 0
  v_mov_b32 v175, 0
  v_lshlrev_b32 v176, 16, v112
  v_and_b32 v177, 0xffff0000, v112
  v_pk_add_f32 v[168:169], v[168:169], v[176:177]
  v_lshlrev_b32 v178, 16, v113
  v_and_b32 v179, 0xffff0000, v113
  v_pk_add_f32 v[170:171], v[170:171], v[178:179]
  v_lshlrev_b32 v176, 16, v114
  v_and_b32 v177, 0xffff0000, v114
  v_pk_add_f32 v[172:173], v[172:173], v[176:177]
  v_lshlrev_b32 v178, 16, v115
  v_and_b32 v179, 0xffff0000, v115
  v_pk_add_f32 v[174:175], v[174:175], v[178:179]
  v_lshlrev_b32 v176, 16, v116
  v_and_b32 v177, 0xffff0000, v116
  v_pk_add_f32 v[168:169], v[168:169], v[176:177]
  v_lshlrev_b32 v178, 16, v117
  v_and_b32 v179, 0xffff0000, v117
  v_pk_add_f32 v[170:171], v[170:171], v[178:179]
  v_lshlrev_b32 v176, 16, v118
  v_and_b32 v177, 0xffff0000, v118
  v_pk_add_f32 v[172:173], v[172:173], v[176:177]
  v_lshlrev_b32 v178, 16, v119
  v_and_b32 v179, 0xffff0000, v119
  v_pk_add_f32 v[174:175], v[174:175], v[178:179]
  v_lshlrev_b32 v176, 16, v120
  v_and_b32 v177, 0xffff0000, v120
  v_pk_add_f32 v[168:169], v[168:169], v[176:177]
  v_lshlrev_b32 v178, 16, v121
  v_and_b32 v179, 0xffff0000, v121
  v_pk_add_f32 v[170:171], v[170:171], v[178:179]
  v_lshlrev_b32 v176, 16, v122
  v_and_b32 v177, 0xffff0000, v122
  v_pk_add_f32 v[172:173], v[172:173], v[176:177]
  v_lshlrev_b32 v178, 16, v123
  v_and_b32 v179, 0xffff0000, v123
  v_pk_add_f32 v[174:175], v[174:175], v[178:179]
  v_lshlrev_b32 v176, 16, v124
  v_and_b32 v177, 0xffff0000, v124
  v_pk_add_f32 v[168:169], v[168:169], v[176:177]
  v_lshlrev_b32 v178, 16, v125
  v_and_b32 v179, 0xffff0000, v125
  v_pk_add_f32 v[170:171], v[170:171], v[178:179]
  v_lshlrev_b32 v176, 16, v126
  v_and_b32 v177, 0xffff0000, v126
  v_pk_add_f32 v[172:173], v[172:173], v[176:177]
  v_lshlrev_b32 v178, 16, v127
  v_and_b32 v179, 0xffff0000, v127
  v_pk_add_f32 v[174:175], v[174:175], v[178:179]
  v_lshlrev_b32 v176, 16, v128
  v_and_b32 v177, 0xffff0000, v128
  v_pk_add_f32 v[168:169], v[168:169], v[176:177]
  v_lshlrev_b32 v178, 16, v129
  v_and_b32 v179, 0xffff0000, v129
  v_pk_add_f32 v[170:171], v[170:171], v[178:179]
  v_lshlrev_b32 v176, 16, v130
  v_and_b32 v177, 0xffff0000, v130
  v_pk_add_f32 v[172:173], v[172:173], v[176:177]
  v_lshlrev_b32 v178, 16, v131
  v_and_b32 v179, 0xffff0000, v131
  v_pk_add_f32 v[174:175], v[174:175], v[178:179]
  v_lshlrev_b32 v176, 16, v132
  v_and_b32 v177, 0xffff0000, v132
  v_pk_add_f32 v[168:169], v[168:169], v[176:177]
  v_lshlrev_b32 v178, 16, v133
  v_and_b32 v179, 0xffff0000, v133
  v_pk_add_f32 v[170:171], v[170:171], v[178:179]
  v_lshlrev_b32 v176, 16, v134
  v_and_b32 v177, 0xffff0000, v134
  v_pk_add_f32 v[172:173], v[172:173], v[176:177]
  v_lshlrev_b32 v178, 16, v135
  v_and_b32 v179, 0xffff0000, v135
  v_pk_add_f32 v[174:175], v[174:175], v[178:179]
  v_lshlrev_b32 v176, 16, v136
  v_and_b32 v177, 0xffff0000, v136
  v_pk_add_f32 v[168:169], v[168:169], v[176:177]
  v_lshlrev_b32 v178, 16, v137
  v_and_b32 v179, 0xffff0000, v137
  v_pk_add_f32 v[170:171], v[170:171], v[178:179]
  v_lshlrev_b32 v176, 16, v138
  v_and_b32 v177, 0xffff0000, v138
  v_pk_add_f32 v[172:173], v[172:173], v[176:177]
  v_lshlrev_b32 v178, 16, v139
  v_and_b32 v179, 0xffff0000, v139
  v_pk_add_f32 v[174:175], v[174:175], v[178:179]
  v_lshlrev_b32 v176, 16, v140
  v_and_b32 v177, 0xffff0000, v140
  v_pk_add_f32 v[168:169], v[168:169], v[176:177]
  v_lshlrev_b32 v178, 16, v141
  v_and_b32 v179, 0xffff0000, v141
  v_pk_add_f32 v[170:171], v[170:171], v[178:179]
  v_lshlrev_b32 v176, 16, v142
  v_and_b32 v177, 0xffff0000, v142
  v_pk_add_f32 v[172:173], v[172:173], v[176:177]
  v_lshlrev_b32 v178, 16, v143
  v_and_b32 v179, 0xffff0000, v143
  v_pk_add_f32 v[174:175], v[174:175], v[178:179]
  v_lshlrev_b32 v176, 16, v144
  v_and_b32 v177, 0xffff0000, v144
  v_pk_add_f32 v[168:169], v[168:169], v[176:177]
  v_lshlrev_b32 v178, 16, v145
  v_and_b32 v179, 0xffff0000, v145
  v_pk_add_f32 v[170:171], v[170:171], v[178:179]
  v_lshlrev_b32 v176, 16, v146
  v_and_b32 v177, 0xffff0000, v146
  v_pk_add_f32 v[172:173], v[172:173], v[176:177]
  v_lshlrev_b32 v178, 16, v147
  v_and_b32 v179, 0xffff0000, v147
  v_pk_add_f32 v[174:175], v[174:175], v[178:179]
  v_lshlrev_b32 v176, 16, v148
  v_and_b32 v177, 0xffff0000, v148
  v_pk_add_f32 v[168:169], v[168:169], v[176:177]
  v_lshlrev_b32 v178, 16, v149
  v_and_b32 v179, 0xffff0000, v149
  v_pk_add_f32 v[170:171], v[170:171], v[178:179]
  v_lshlrev_b32 v176, 16, v150
  v_and_b32 v177, 0xffff0000, v150
  v_pk_add_f32 v[172:173], v[172:173], v[176:177]
  v_lshlrev_b32 v178, 16, v151
  v_and_b32 v179, 0xffff0000, v151
  v_pk_add_f32 v[174:175], v[174:175], v[178:179]
  v_lshlrev_b32 v176, 16, v152
  v_and_b32 v177, 0xffff0000, v152
  v_pk_add_f32 v[168:169], v[168:169], v[176:177]
  v_lshlrev_b32 v178, 16, v153
  v_and_b32 v179, 0xffff0000, v153
  v_pk_add_f32 v[170:171], v[170:171], v[178:179]
  v_lshlrev_b32 v176, 16, v154
  v_and_b32 v177, 0xffff0000, v154
  v_pk_add_f32 v[172:173], v[172:173], v[176:177]
  v_lshlrev_b32 v178, 16, v155
  v_and_b32 v179, 0xffff0000, v155
  v_pk_add_f32 v[174:175], v[174:175], v[178:179]
  v_lshlrev_b32 v176, 16, v156
  v_and_b32 v177, 0xffff0000, v156
  v_pk_add_f32 v[168:169], v[168:169], v[176:177]
  v_lshlrev_b32 v178, 16, v157
  v_and_b32 v179, 0xffff0000, v157
  v_pk_add_f32 v[170:171], v[170:171], v[178:179]
  v_lshlrev_b32 v176, 16, v158
  v_and_b32 v177, 0xffff0000, v158
  v_pk_add_f32 v[172:173], v[172:173], v[176:177]
  v_lshlrev_b32 v178, 16, v159
  v_and_b32 v179, 0xffff0000, v159
  v_pk_add_f32 v[174:175], v[174:175], v[178:179]
  v_lshlrev_b32 v176, 16, v160
  v_and_b32 v177, 0xffff0000, v160
  v_pk_add_f32 v[168:169], v[168:169], v[176:177]
  v_lshlrev_b32 v178, 16, v161
  v_and_b32 v179, 0xffff0000, v161
  v_pk_add_f32 v[170:171], v[170:171], v[178:179]
  v_lshlrev_b32 v176, 16, v162
  v_and_b32 v177, 0xffff0000, v162
  v_pk_add_f32 v[172:173], v[172:173], v[176:177]
  v_lshlrev_b32 v178, 16, v163
  v_and_b32 v179, 0xffff0000, v163
  v_pk_add_f32 v[174:175], v[174:175], v[178:179]
  v_lshlrev_b32 v176, 16, v164
  v_and_b32 v177, 0xffff0000, v164
  v_pk_add_f32 v[168:169], v[168:169], v[176:177]
  v_lshlrev_b32 v178, 16, v165
  v_and_b32 v179, 0xffff0000, v165
  v_pk_add_f32 v[170:171], v[170:171], v[178:179]
  v_lshlrev_b32 v176, 16, v166
  v_and_b32 v177, 0xffff0000, v166
  v_pk_add_f32 v[172:173], v[172:173], v[176:177]
  v_lshlrev_b32 v178, 16, v167
  v_and_b32 v179, 0xffff0000, v167
  v_pk_add_f32 v[174:175], v[174:175], v[178:179]
  s_lshl_b32 s6, s4, 11
  v_lshlrev_b32 v180, 8, v3
  v_lshl_add_u32 v180, v4, 5, v180
  v_add_u32 v180, s6, v180
  ds_write_b128 v180, v[168:171]
  ds_write_b128 v180, v[172:175] offset:16
  s_waitcnt lgkmcnt(0)
  s_barrier
  s_cmp_lg_u32 s4, 0
  s_cbranch_scc1 L_hcs_b
  v_lshlrev_b32 v180, 2, v1
  ds_read_b32 v112, v180 offset:0
  ds_read_b32 v113, v180 offset:256
  ds_read_b32 v114, v180 offset:512
  ds_read_b32 v115, v180 offset:768
  ds_read_b32 v116, v180 offset:1024
  ds_read_b32 v117, v180 offset:1280
  ds_read_b32 v118, v180 offset:1536
  ds_read_b32 v119, v180 offset:1792
  ds_read_b32 v120, v180 offset:2048
  ds_read_b32 v121, v180 offset:2304
  ds_read_b32 v122, v180 offset:2560
  ds_read_b32 v123, v180 offset:2816
  ds_read_b32 v124, v180 offset:3072
  ds_read_b32 v125, v180 offset:3328
  ds_read_b32 v126, v180 offset:3584
  ds_read_b32 v127, v180 offset:3840
  ds_read_b32 v128, v180 offset:4096
  ds_read_b32 v129, v180 offset:4352
  ds_read_b32 v130, v180 offset:4608
  ds_read_b32 v131, v180 offset:4864
  ds_read_b32 v132, v180 offset:5120
  ds_read_b32 v133, v180 offset:5376
  ds_read_b32 v134, v180 offset:5632
  ds_read_b32 v135, v180 offset:5888
  ds_read_b32 v136, v180 offset:6144
  ds_read_b32 v137, v180 offset:6400
  ds_read_b32 v138, v180 offset:6656
  ds_read_b32 v139, v180 offset:6912
  ds_read_b32 v140, v180 offset:7168
  ds_read_b32 v141, v180 offset:7424
  ds_read_b32 v142, v180 offset:7680
  ds_read_b32 v143, v180 offset:7936
  s_waitcnt lgkmcnt(0)
  v_add_f32 v112, v112, v128
  v_add_f32 v113, v113, v129
  v_add_f32 v114, v114, v130
  v_add_f32 v115, v115, v131
  v_add_f32 v116, v116, v132
  v_add_f32 v117, v117, v133
  v_add_f32 v118, v118, v134
  v_add_f32 v119, v119, v135
  v_add_f32 v120, v120, v136
  v_add_f32 v121, v121, v137
  v_add_f32 v122, v122, v138
  v_add_f32 v123, v123, v139
  v_add_f32 v124, v124, v140
  v_add_f32 v125, v125, v141
  v_add_f32 v126, v126, v142
  v_add_f32 v127, v127, v143
  v_add_f32 v112, v112, v120
  v_add_f32 v113, v113, v121
  v_add_f32 v114, v114, v122
  v_add_f32 v115, v115, v123
  v_add_f32 v116, v116, v124
  v_add_f32 v117, v117, v125
  v_add_f32 v118, v118, v126
  v_add_f32 v119, v119, v127
  v_add_f32 v112, v112, v116
  v_add_f32 v113, v113, v117
  v_add_f32 v114, v114, v118
  v_add_f32 v115, v115, v119
  v_add_f32 v112, v112, v114
  v_add_f32 v113, v113, v115
  v_add_f32 v112, v112, v113
  v_cvt_pk_bf16_f32 v144, v112, v112
  v_and_b32 v144, 0xffff0000, v144
  v_sub_f32 v144, v112, v144
  v_cvt_pk_bf16_f32 v144, v112, v144
  v_mov_b32 v145, s50
  s_lshl_b32 s6, s2, 9
  s_add_u32 s6, s6, 12632064
  v_lshl_add_u32 v146, v1, 3, s6
  buffer_store_dwordx2 v[144:145], v146, s[28:31], 0 offen sc1
        L_hcs_b:
  v_mov_b32 v72, 0
  v_mov_b32 v73, 0
  v_mov_b32 v74, 0
  v_mov_b32 v75, 0
  v_mov_b32 v76, 0
  v_mov_b32 v77, 0
  v_mov_b32 v78, 0
  v_mov_b32 v79, 0
  v_mov_b32 v80, 0
  v_mov_b32 v81, 0
  v_mov_b32 v82, 0
  v_mov_b32 v83, 0
  v_mov_b32 v84, 0
  v_mov_b32 v85, 0
  v_mov_b32 v86, 0
  v_mov_b32 v87, 0
  s_waitcnt vmcnt(17)
  v_dot2c_f32_bf16 v72, v16, v9
  v_dot2c_f32_bf16 v76, v16, v16
  v_dot2c_f32_bf16 v73, v17, v9
  v_dot2c_f32_bf16 v77, v17, v17
  v_dot2c_f32_bf16 v74, v18, v9
  v_dot2c_f32_bf16 v78, v18, v18
  v_dot2c_f32_bf16 v75, v19, v9
  v_dot2c_f32_bf16 v79, v19, v19
  v_dot2c_f32_bf16 v72, v20, v9
  v_dot2c_f32_bf16 v76, v20, v20
  v_dot2c_f32_bf16 v73, v21, v9
  v_dot2c_f32_bf16 v77, v21, v21
  v_dot2c_f32_bf16 v74, v22, v9
  v_dot2c_f32_bf16 v78, v22, v22
  v_dot2c_f32_bf16 v75, v23, v9
  v_dot2c_f32_bf16 v79, v23, v23
  v_dot2c_f32_bf16 v72, v24, v9
  v_dot2c_f32_bf16 v76, v24, v24
  v_dot2c_f32_bf16 v73, v25, v9
  v_dot2c_f32_bf16 v77, v25, v25
  v_dot2c_f32_bf16 v74, v26, v9
  v_dot2c_f32_bf16 v78, v26, v26
  v_dot2c_f32_bf16 v75, v27, v9
  v_dot2c_f32_bf16 v79, v27, v27
  v_dot2c_f32_bf16 v72, v28, v9
  v_dot2c_f32_bf16 v76, v28, v28
  v_dot2c_f32_bf16 v73, v29, v9
  v_dot2c_f32_bf16 v77, v29, v29
  v_dot2c_f32_bf16 v74, v30, v9
  v_dot2c_f32_bf16 v78, v30, v30
  v_dot2c_f32_bf16 v75, v31, v9
  v_dot2c_f32_bf16 v79, v31, v31
  v_dot2c_f32_bf16 v72, v32, v9
  v_dot2c_f32_bf16 v76, v32, v32
  v_dot2c_f32_bf16 v73, v33, v9
  v_dot2c_f32_bf16 v77, v33, v33
  v_dot2c_f32_bf16 v74, v34, v9
  v_dot2c_f32_bf16 v78, v34, v34
  v_dot2c_f32_bf16 v75, v35, v9
  v_dot2c_f32_bf16 v79, v35, v35
  v_dot2c_f32_bf16 v72, v36, v9
  v_dot2c_f32_bf16 v76, v36, v36
  v_dot2c_f32_bf16 v73, v37, v9
  v_dot2c_f32_bf16 v77, v37, v37
  v_dot2c_f32_bf16 v74, v38, v9
  v_dot2c_f32_bf16 v78, v38, v38
  v_dot2c_f32_bf16 v75, v39, v9
  v_dot2c_f32_bf16 v79, v39, v39
  v_dot2c_f32_bf16 v72, v40, v9
  v_dot2c_f32_bf16 v76, v40, v40
  v_dot2c_f32_bf16 v73, v41, v9
  v_dot2c_f32_bf16 v77, v41, v41
  v_dot2c_f32_bf16 v74, v42, v9
  v_dot2c_f32_bf16 v78, v42, v42
  v_dot2c_f32_bf16 v75, v43, v9
  v_dot2c_f32_bf16 v79, v43, v43
  s_waitcnt vmcnt(10)
  v_dot2c_f32_bf16 v80, v44, v9
  v_dot2c_f32_bf16 v84, v44, v44
  v_dot2c_f32_bf16 v81, v45, v9
  v_dot2c_f32_bf16 v85, v45, v45
  v_dot2c_f32_bf16 v82, v46, v9
  v_dot2c_f32_bf16 v86, v46, v46
  v_dot2c_f32_bf16 v83, v47, v9
  v_dot2c_f32_bf16 v87, v47, v47
  v_dot2c_f32_bf16 v80, v48, v9
  v_dot2c_f32_bf16 v84, v48, v48
  v_dot2c_f32_bf16 v81, v49, v9
  v_dot2c_f32_bf16 v85, v49, v49
  v_dot2c_f32_bf16 v82, v50, v9
  v_dot2c_f32_bf16 v86, v50, v50
  v_dot2c_f32_bf16 v83, v51, v9
  v_dot2c_f32_bf16 v87, v51, v51
  v_dot2c_f32_bf16 v80, v52, v9
  v_dot2c_f32_bf16 v84, v52, v52
  v_dot2c_f32_bf16 v81, v53, v9
  v_dot2c_f32_bf16 v85, v53, v53
  v_dot2c_f32_bf16 v82, v54, v9
  v_dot2c_f32_bf16 v86, v54, v54
  v_dot2c_f32_bf16 v83, v55, v9
  v_dot2c_f32_bf16 v87, v55, v55
  v_dot2c_f32_bf16 v80, v56, v9
  v_dot2c_f32_bf16 v84, v56, v56
  v_dot2c_f32_bf16 v81, v57, v9
  v_dot2c_f32_bf16 v85, v57, v57
  v_dot2c_f32_bf16 v82, v58, v9
  v_dot2c_f32_bf16 v86, v58, v58
  v_dot2c_f32_bf16 v83, v59, v9
  v_dot2c_f32_bf16 v87, v59, v59
  v_dot2c_f32_bf16 v80, v60, v9
  v_dot2c_f32_bf16 v84, v60, v60
  v_dot2c_f32_bf16 v81, v61, v9
  v_dot2c_f32_bf16 v85, v61, v61
  v_dot2c_f32_bf16 v82, v62, v9
  v_dot2c_f32_bf16 v86, v62, v62
  v_dot2c_f32_bf16 v83, v63, v9
  v_dot2c_f32_bf16 v87, v63, v63
  v_dot2c_f32_bf16 v80, v64, v9
  v_dot2c_f32_bf16 v84, v64, v64
  v_dot2c_f32_bf16 v81, v65, v9
  v_dot2c_f32_bf16 v85, v65, v65
  v_dot2c_f32_bf16 v82, v66, v9
  v_dot2c_f32_bf16 v86, v66, v66
  v_dot2c_f32_bf16 v83, v67, v9
  v_dot2c_f32_bf16 v87, v67, v67
  v_dot2c_f32_bf16 v80, v68, v9
  v_dot2c_f32_bf16 v84, v68, v68
  v_dot2c_f32_bf16 v81, v69, v9
  v_dot2c_f32_bf16 v85, v69, v69
  v_dot2c_f32_bf16 v82, v70, v9
  v_dot2c_f32_bf16 v86, v70, v70
  v_dot2c_f32_bf16 v83, v71, v9
  v_dot2c_f32_bf16 v87, v71, v71
  s_nop 4
  v_add_f32 v72, v72, v73
  v_add_f32 v74, v74, v75
  v_add_f32 v76, v76, v77
  v_add_f32 v78, v78, v79
  v_add_f32 v72, v72, v74
  v_add_f32 v76, v76, v78
  v_add_f32 v80, v80, v81
  v_add_f32 v82, v82, v83
  v_add_f32 v84, v84, v85
  v_add_f32 v86, v86, v87
  v_add_f32 v80, v80, v82
  v_add_f32 v84, v84, v86
  s_nop 1
  v_add_f32_dpp v72, v72, v72 quad_perm:[1,0,3,2] row_mask:0xf bank_mask:0xf
  v_add_f32_dpp v76, v76, v76 quad_perm:[1,0,3,2] row_mask:0xf bank_mask:0xf
  v_add_f32_dpp v80, v80, v80 quad_perm:[1,0,3,2] row_mask:0xf bank_mask:0xf
  v_add_f32_dpp v84, v84, v84 quad_perm:[1,0,3,2] row_mask:0xf bank_mask:0xf
  s_nop 1
  v_add_f32_dpp v72, v72, v72 quad_perm:[2,3,0,1] row_mask:0xf bank_mask:0xf
  v_add_f32_dpp v76, v76, v76 quad_perm:[2,3,0,1] row_mask:0xf bank_mask:0xf
  v_add_f32_dpp v80, v80, v80 quad_perm:[2,3,0,1] row_mask:0xf bank_mask:0xf
  v_add_f32_dpp v84, v84, v84 quad_perm:[2,3,0,1] row_mask:0xf bank_mask:0xf
  s_nop 1
  v_add_f32_dpp v72, v72, v72 row_half_mirror row_mask:0xf bank_mask:0xf
  v_add_f32_dpp v76, v76, v76 row_half_mirror row_mask:0xf bank_mask:0xf
  v_add_f32_dpp v80, v80, v80 row_half_mirror row_mask:0xf bank_mask:0xf
  v_add_f32_dpp v84, v84, v84 row_half_mirror row_mask:0xf bank_mask:0xf
  s_mov_b32 s52, 0x3b124925
  v_mul_f32 v72, s52, v72
  v_mul_f32 v76, s52, v76
  v_fma_f32 v76, -v72, v72, v76
  v_max_f32 v76, 0, v76
  v_cvt_pk_bf16_f32 v76, v76, v76
  v_and_b32 v76, 0xffff0000, v76
  v_add_f32 v76, 0x3727c5ac, v76
  v_cvt_pk_bf16_f32 v76, v76, v76
  v_and_b32 v76, 0xffff0000, v76
  v_sqrt_f32 v76, v76
  s_nop 0
  v_cvt_pk_bf16_f32 v90, v72, v76
  v_mov_b32 v91, s50
  v_mul_f32 v80, s52, v80
  v_mul_f32 v84, s52, v84
  v_fma_f32 v84, -v80, v80, v84
  v_max_f32 v84, 0, v84
  v_cvt_pk_bf16_f32 v84, v84, v84
  v_and_b32 v84, 0xffff0000, v84
  v_add_f32 v84, 0x3727c5ac, v84
  v_cvt_pk_bf16_f32 v84, v84, v84
  v_and_b32 v84, 0xffff0000, v84
  v_sqrt_f32 v84, v84
  s_nop 0
  v_cvt_pk_bf16_f32 v92, v80, v84
  v_mov_b32 v93, s50
  v_lshlrev_b32 v11, 3, v5
  v_add_u32 v11, 12615680, v11
  s_mov_b32 exec_lo, 0x01010101
  s_mov_b32 exec_hi, 0x01010101
  buffer_store_dwordx2 v[90:91], v11, s[28:31], 0 offen sc1
  buffer_store_dwordx2 v[92:93], v11, s[28:31], 0 offen offset:64 sc1
  s_mov_b64 exec, -1
  s_lshl_b32 s52, s2, 2
  s_add_u32 s52, s52, s4
  s_lshl_b32 s52, s52, 2
  s_add_u32 s52, s52, 12590592
  v_mov_b32 v12, s52
  v_mov_b32 v13, s50
  s_mov_b64 exec, 1
  buffer_store_dword v13, v12, s[28:31], 0 offen sc1
  s_mov_b64 exec, -1
  v_lshlrev_b32 v14, 4, v0
  s_mov_b32 s16, s82
  s_mov_b32 s17, s83
  s_mov_b32 s18, 1605632
  s_mov_b32 s19, 0x00020000
  s_mul_i32 s10, s2, 50176
  s_add_u32 s10, s10, 0
  buffer_load_dwordx4 v[16:19], v14, s[16:19], s10 offen
  s_add_u32 s10, s10, 4096
  buffer_load_dwordx4 v[20:23], v14, s[16:19], s10 offen
  s_add_u32 s10, s10, 4096
  buffer_load_dwordx4 v[24:27], v14, s[16:19], s10 offen
  s_add_u32 s10, s10, 4096
  buffer_load_dwordx4 v[28:31], v14, s[16:19], s10 offen
  s_add_u32 s10, s10, 4096
  buffer_load_dwordx4 v[16:19], v14, s[16:19], s10 offen
  s_add_u32 s10, s10, 4096
  buffer_load_dwordx4 v[20:23], v14, s[16:19], s10 offen
  s_add_u32 s10, s10, 4096
  buffer_load_dwordx4 v[24:27], v14, s[16:19], s10 offen
  s_add_u32 s10, s10, 4096
  buffer_load_dwordx4 v[28:31], v14, s[16:19], s10 offen
  s_add_u32 s10, s10, 4096
  buffer_load_dwordx4 v[16:19], v14, s[16:19], s10 offen
  s_add_u32 s10, s10, 4096
  buffer_load_dwordx4 v[20:23], v14, s[16:19], s10 offen
  s_add_u32 s10, s10, 4096
  buffer_load_dwordx4 v[24:27], v14, s[16:19], s10 offen
  s_add_u32 s10, s10, 4096
  buffer_load_dwordx4 v[28:31], v14, s[16:19], s10 offen
  s_add_u32 s10, s10, 4096
  buffer_load_dwordx4 v[16:19], v14, s[16:19], s10 offen
  s_add_u32 s10, s10, 4096
L_hend:
  s_endpgm
.fill 1024, 4, 0xbf810000
.if (. - L_pc) < 20480
.error "code prefetch range exceeds the code"
.endif

.section .rodata,"a"
.p2align 6
.amdhsa_kernel parallel_sum__ssm_conv_h3__dense_activation_mish__prompt_kernel
  .amdhsa_next_free_vgpr 512
  .amdhsa_next_free_sgpr 100
  .amdhsa_accum_offset 256
  .amdhsa_group_segment_fixed_size 0
  .amdhsa_kernarg_size 104
  .amdhsa_user_sgpr_count 2
  .amdhsa_user_sgpr_kernarg_segment_ptr 1
  .amdhsa_system_sgpr_workgroup_id_x 1
  .amdhsa_ieee_mode 0
.end_amdhsa_kernel
```
